```python
import torch

def _softmax(x, axis=-1):
    return torch.softmax(x, dim=axis)
def _gelu(x):
    return torch.nn.functional.gelu(x, approximate="tanh")
def _silu(x):
    return torch.nn.functional.silu(x)
def _sigmoid(x):
    return torch.sigmoid(x)
def _layernorm(x, axis=-1, eps=1e-5):
    m = x.mean(dim=axis, keepdim=True)
    v = x.var(dim=axis, keepdim=True, unbiased=False)
    return (x - m) / torch.sqrt(v + eps)
def _scatter_add(tgt, idx, src, axis=0):
    return tgt.clone().index_add_(axis, idx, src)
def _segment_sum(src, seg, n):
    out = torch.zeros((n,) + src.shape[1:], dtype=src.dtype)
    return out.index_add_(0, seg, src)
def _pad(x, pw):
    flat = tuple(v for pair in reversed(pw) for v in pair)
    return torch.nn.functional.pad(x, flat)

kernel_name = 'interleave_layers__compressed_kv_cla__mha_block_cached__decode'

def setup_inputs():

    _w = (lambda a: (lambda t: t.to(torch.bfloat16) if t.is_floating_point() else t)(torch.as_tensor(a)))
    def _A_setup():
        B, H, Sq, Sk, D, M = 1, 32, 1, 8192, 128, 640
        Dc = 4 * D
        return {
            "x": _w((lambda *s: torch.randn(*s, dtype=torch.bfloat16) * 0.05)(B, Sq, M)),
            "c_kv": _w((lambda *s: torch.randn(*s, dtype=torch.bfloat16) * 1.6)(B, Sk, Dc)),
            "w_q": _w((lambda *s: torch.randn(*s, dtype=torch.bfloat16) * 0.8)(M, H, D) * (M ** -0.5)),
            "w_uk": _w((lambda *s: torch.randn(*s, dtype=torch.bfloat16) * 0.8)(Dc, H, D) * (Dc ** -0.5)),
            "w_uv": _w((lambda *s: torch.randn(*s, dtype=torch.bfloat16) * 1.6)(Dc, H, D) * (Dc ** -0.5)),
            "w_o": _w((lambda *s: torch.randn(*s, dtype=torch.bfloat16) * 1.6)(H, D, M) * ((H * D) ** -0.5)),
        }
    _A_in = _A_setup()

    def _B_setup():
        B, Sq, D = 1, 1, 640
        H, Sk, Dh = 32, 8192, 128
        return {
            "x": _w((lambda *s: torch.randn(*s, dtype=torch.bfloat16) * 0.05)(B, Sq, D)),
            "k_cache": _w((lambda *s: torch.randn(*s, dtype=torch.bfloat16) * 3.2)(B, H, Sk, Dh)),
            "v_cache": _w((lambda *s: torch.randn(*s, dtype=torch.bfloat16) * 0.4)(B, H, Sk, Dh)),
            "wq": _w((lambda *s: torch.randn(*s, dtype=torch.bfloat16) * 3.2)(D, H * Dh) * (D ** -0.5)),
            "wo": _w((lambda *s: torch.randn(*s, dtype=torch.bfloat16) * 0.4)(H * Dh, D) * ((H * Dh) ** -0.5)),
        }
    _B_in = _B_setup()

    return {
        "A_x": _A_in["x"],
        "A_c_kv": _A_in["c_kv"],
        "A_w_q": _A_in["w_q"],
        "A_w_uk": _A_in["w_uk"],
        "A_w_uv": _A_in["w_uv"],
        "A_w_o": _A_in["w_o"],
        "B_x": _B_in["x"],
        "B_k_cache": _B_in["k_cache"],
        "B_v_cache": _B_in["v_cache"],
        "B_wq": _B_in["wq"],
        "B_wo": _B_in["wo"],
    }

def reference(A_x, A_c_kv, A_w_q, A_w_uk, A_w_uv, A_w_o, B_x, B_k_cache, B_v_cache, B_wq, B_wo):
    def _A_ref(x, c_kv, w_q, w_uk, w_uv, w_o):
        B, Sq, M = x.shape[0], x.shape[1], x.shape[2]
        Sk = c_kv.shape[1]
        H, D = w_q.shape[1], w_q.shape[2]
        q = torch.einsum("bqm,mhd->bhqd", x, w_q)
        k = torch.einsum("bkc,chd->bhkd", c_kv, w_uk)
        v = torch.einsum("bkc,chd->bhkd", c_kv, w_uv)
        scores = torch.einsum("bhqd,bhkd->bhqk", q, k) * (D ** -0.5)
        off = Sk - Sq
        qi = torch.arange(Sq)[:, None]
        kj = torch.arange(Sk)[None, :]
        cmask = kj <= (qi + off)
        scores = torch.where(cmask[None, None], scores, -1e9)
        p = _softmax(scores, axis=-1)
        ctx = torch.einsum("bhqk,bhkd->bhqd", p, v)
        return torch.einsum("bhqd,hdm->bqm", ctx, w_o)

    def _B_ref(x, k_cache, v_cache, wq, wo):
        B, Sq, D = x.shape
        H, Dh = 32, 128
        q = (lambda x, *d: x.permute(*d))((x @ wq).reshape(B, Sq, H, Dh), 0, 2, 1, 3)
        scores = torch.einsum("bhqd,bhkd->bhqk", q, k_cache) * (Dh ** -0.5)
        p = _softmax(scores, axis=-1)
        o = torch.einsum("bhqk,bhkd->bhqd", p, v_cache)
        return (lambda x, *d: x.permute(*d))(o, 0, 2, 1, 3).reshape(B, Sq, H * Dh) @ wo

    x = A_x
    x = x + _A_ref(_layernorm(x, axis=-1), A_c_kv, A_w_q, A_w_uk, A_w_uv, A_w_o)
    x = x + _B_ref(_layernorm(x, axis=-1), B_k_cache, B_v_cache, B_wq, B_wo)
    x = x + _A_ref(_layernorm(x, axis=-1), A_c_kv, A_w_q, A_w_uk, A_w_uv, A_w_o)
    x = x + _B_ref(_layernorm(x, axis=-1), B_k_cache, B_v_cache, B_wq, B_wo)
    return x
```

```asm
; @launch grid=(256,1,1) block=(256,1,1) lds=163840
.amdgcn_target "amdgcn-amd-amdhsa--gfx950"
.text
.globl interleave_layers__compressed_kv_cla__mha_block_cached__decode_kernel
.p2align 8
.type interleave_layers__compressed_kv_cla__mha_block_cached__decode_kernel,@function
interleave_layers__compressed_kv_cla__mha_block_cached__decode_kernel:
    s_cmp_ge_u32 s2, 256
    s_cbranch_scc1 L_end
    s_load_dwordx16 s[40:55], s[0:1], 0
    s_load_dwordx8 s[56:63], s[0:1], 64
    s_load_dwordx4 s[64:67], s[0:1], 96
    v_lshrrev_b32 v8, 6, v0
    v_and_b32 v0, 63, v0
    v_readfirstlane_b32 s68, v8
    s_and_b32 s78, s2, 7
    s_lshr_b32 s79, s2, 3
    s_lshr_b32 s96, s79, 3
    s_and_b32 s97, s96, 1
    s_lshl_b32 s69, s78, 1
    s_add_u32 s69, s69, s97
    s_lshr_b32 s73, s96, 1
    s_lshl_b32 s97, s73, 4
    s_add_u32 s69, s69, s97
    s_and_b32 s70, s79, 7
    s_lshl_b32 s71, s69, 3
    s_add_u32 s71, s71, s70
    s_and_b32 s72, s71, 127
    s_lshl_b32 s96, s68, 13
    s_add_u32 s20, s96, 65536
    s_add_u32 s21, s96, 98304
    s_lshl_b32 s96, s68, 12
    s_add_u32 s22, s96, 131072
    s_lshl_b32 s23, s68, 14
    v_lshlrev_b32 v1, 4, v0
    s_mov_b32 s74, 1
    s_mov_b32 s77, 0
    v_and_b32 v8, 15, v0
    v_lshrrev_b32 v9, 4, v0
    v_lshl_add_u32 v9, v8, 2, v9
    s_mul_i32 s78, s70, 80
    s_mul_i32 s79, s68, 20
    s_add_u32 s78, s78, s79
    v_add_u32 v9, s78, v9
    v_lshlrev_b32 v9, 1, v9
    v_cmp_gt_u32 vcc, 5, v8
    v_mov_b32 v10, 0x10000
    s_nop 0
    v_cndmask_b32 v9, v10, v9, vcc
    s_waitcnt lgkmcnt(0)
    s_mov_b32 s4, s66
    s_mov_b32 s5, s67
    s_mov_b32 s6, 12582912
    s_mov_b32 s7, 0x20000
    v_mov_b32 v12, -1
    v_mov_b32 v13, -1
    v_mov_b32 v14, -1
    v_mov_b32 v15, -1
    s_cmp_lg_u32 s70, 7
    s_cbranch_scc1 L_noclean_1
    s_lshl_b32 s79, s69, 2
    s_add_u32 s79, s79, s68
    s_mul_i32 s79, s79, 3072
    buffer_store_dwordx4 v[12:15], v1, s[4:7], s79 offen offset:0 sc1
    buffer_store_dwordx4 v[12:15], v1, s[4:7], s79 offen offset:1024 sc1
    buffer_store_dwordx4 v[12:15], v1, s[4:7], s79 offen offset:2048 sc1
L_noclean_1:
    s_mov_b32 s8, s40
    s_mov_b32 s9, s41
    s_mov_b32 s10, 1280
    s_mov_b32 s11, 0x20000
    buffer_load_ushort v6, v9, s[8:11], 0 offen
    s_mov_b32 s8, s44
    s_mov_b32 s9, s45
    s_mov_b32 s10, 5242880
    s_mov_b32 s11, 0x20000
    s_mul_i32 s79, s70, 655360
    s_mul_i32 s99, s68, 163840
    s_add_u32 s79, s79, s99
    s_mul_i32 s99, s69, 256
    s_add_u32 s79, s79, s99
    v_lshrrev_b32 v62, 4, v0
    s_mov_b32 s99, 8192
    v_mul_lo_u32 v62, v62, s99
    v_and_b32 v63, 0xf0, v1
    v_add_u32 v62, v62, v63
    s_add_u32 m0, s21, 0
    s_add_u32 s78, s79, 0
    buffer_load_dwordx4 v62, s[8:11], s78 offen nt lds
    s_add_u32 m0, s21, 1024
    s_add_u32 s78, s79, 32768
    buffer_load_dwordx4 v62, s[8:11], s78 offen nt lds
    s_add_u32 m0, s21, 2048
    s_add_u32 s78, s79, 65536
    buffer_load_dwordx4 v62, s[8:11], s78 offen nt lds
    s_add_u32 m0, s21, 3072
    s_add_u32 s78, s79, 98304
    buffer_load_dwordx4 v62, s[8:11], s78 offen nt lds
    s_add_u32 m0, s21, 4096
    s_add_u32 s78, s79, 131072
    buffer_load_dwordx4 v62, s[8:11], s78 offen nt lds
    s_cmp_lg_u32 s70, 7
    s_cbranch_scc1 L_noflag_2
    s_waitcnt vmcnt(6)
    s_barrier
    s_cmp_lg_u32 s68, 3
    s_cbranch_scc1 L_noflag_2
    s_mov_b32 s8, s64
    s_mov_b32 s9, s65
    s_mov_b32 s10, 256
    s_mov_b32 s11, 0x20000
    s_lshl_b32 s79, 1, s69
    v_mov_b32 v16, s79
    s_mov_b64 exec, 1
    buffer_atomic_or v16, off, s[8:11], 0 sc1
    s_mov_b64 exec, -1
L_noflag_2:
    s_mov_b32 s8, s46
    s_mov_b32 s9, s47
    s_mov_b32 s10, 4194304
    s_mov_b32 s11, 0x20000
    s_mul_i32 s79, s70, 524288
    s_mul_i32 s99, s68, 131072
    s_add_u32 s79, s79, s99
    s_mul_i32 s99, s69, 256
    s_add_u32 s79, s79, s99
    v_lshrrev_b32 v62, 4, v0
    s_mov_b32 s99, 32768
    v_mul_lo_u32 v62, v62, s99
    v_and_b32 v63, 0xf0, v1
    v_add_u32 v62, v62, v63
    s_add_u32 m0, s22, 0
    s_add_u32 s78, s79, 0
    buffer_load_dwordx4 v62, s[8:11], s78 offen nt lds
    s_add_u32 m0, s22, 1024
    s_add_u32 s78, s79, 8192
    buffer_load_dwordx4 v62, s[8:11], s78 offen nt lds
    s_add_u32 m0, s22, 2048
    s_add_u32 s78, s79, 16384
    buffer_load_dwordx4 v62, s[8:11], s78 offen nt lds
    s_add_u32 m0, s22, 3072
    s_add_u32 s78, s79, 24576
    buffer_load_dwordx4 v62, s[8:11], s78 offen nt lds
    s_lshl_b32 s79, s71, 14
    s_lshl_b32 s96, s68, 12
    s_add_u32 s79, s79, s96
    s_add_u32 s79, s79, 655360
    buffer_store_dwordx4 v[12:15], v1, s[4:7], s79 offen offset:0 sc1
    buffer_store_dwordx4 v[12:15], v1, s[4:7], s79 offen offset:1024 sc1
    buffer_store_dwordx4 v[12:15], v1, s[4:7], s79 offen offset:2048 sc1
    buffer_store_dwordx4 v[12:15], v1, s[4:7], s79 offen offset:3072 sc1
    s_lshl_b32 s79, s71, 9
    s_mov_b32 s97, 524288
    s_cmp_eq_u32 s68, 0
    s_cselect_b32 s96, 393216, s97
    s_add_u32 s79, s79, s96
    s_mov_b32 exec_lo, -1
    s_mov_b32 exec_hi, 0
    buffer_store_dwordx4 v[12:15], v1, s[4:7], s79 offen sc1
    s_mov_b64 exec, -1
    s_mov_b32 s8, s42
    s_mov_b32 s9, s43
    s_mov_b32 s10, 8388608
    s_mov_b32 s11, 0x20000
    s_mul_i32 s79, s72, 65536
    s_mul_i32 s99, s68, 256
    s_add_u32 s79, s79, s99
    v_lshrrev_b32 v16, 4, v0
    v_and_b32 v17, 15, v0
    v_add_u32 v22, 0, v16
    v_and_b32 v23, 1, v22
    v_and_b32 v18, 6, v22
    v_lshl_or_b32 v23, v18, 1, v23
    v_bfe_u32 v18, v22, 3, 1
    v_lshl_or_b32 v23, v18, 1, v23
    v_xor_b32 v23, v23, v17
    v_lshlrev_b32 v23, 4, v23
    v_lshl_add_u32 v18, v16, 10, v23
    v_add_u32 v22, 4, v16
    v_and_b32 v23, 1, v22
    v_and_b32 v19, 6, v22
    v_lshl_or_b32 v23, v19, 1, v23
    v_bfe_u32 v19, v22, 3, 1
    v_lshl_or_b32 v23, v19, 1, v23
    v_xor_b32 v23, v23, v17
    v_lshlrev_b32 v23, 4, v23
    v_lshl_add_u32 v19, v16, 10, v23
    v_add_u32 v22, 8, v16
    v_and_b32 v23, 1, v22
    v_and_b32 v20, 6, v22
    v_lshl_or_b32 v23, v20, 1, v23
    v_bfe_u32 v20, v22, 3, 1
    v_lshl_or_b32 v23, v20, 1, v23
    v_xor_b32 v23, v23, v17
    v_lshlrev_b32 v23, 4, v23
    v_lshl_add_u32 v20, v16, 10, v23
    v_add_u32 v22, 12, v16
    v_and_b32 v23, 1, v22
    v_and_b32 v21, 6, v22
    v_lshl_or_b32 v23, v21, 1, v23
    v_bfe_u32 v21, v22, 3, 1
    v_lshl_or_b32 v23, v21, 1, v23
    v_xor_b32 v23, v23, v17
    v_lshlrev_b32 v23, 4, v23
    v_lshl_add_u32 v21, v16, 10, v23
    s_add_u32 m0, s20, 0
    s_add_u32 s78, s79, 0
    buffer_load_dwordx4 v18, s[8:11], s78 offen nt lds
    s_add_u32 m0, s20, 1024
    s_add_u32 s78, s79, 4096
    buffer_load_dwordx4 v19, s[8:11], s78 offen nt lds
    s_add_u32 m0, s20, 2048
    s_add_u32 s78, s79, 8192
    buffer_load_dwordx4 v20, s[8:11], s78 offen nt lds
    s_add_u32 m0, s20, 3072
    s_add_u32 s78, s79, 12288
    buffer_load_dwordx4 v21, s[8:11], s78 offen nt lds
    s_add_u32 m0, s20, 4096
    s_add_u32 s78, s79, 16384
    buffer_load_dwordx4 v18, s[8:11], s78 offen nt lds
    s_add_u32 m0, s20, 5120
    s_add_u32 s78, s79, 20480
    buffer_load_dwordx4 v19, s[8:11], s78 offen nt lds
    s_add_u32 m0, s20, 6144
    s_add_u32 s78, s79, 24576
    buffer_load_dwordx4 v20, s[8:11], s78 offen nt lds
    s_add_u32 m0, s20, 7168
    s_add_u32 s78, s79, 28672
    buffer_load_dwordx4 v21, s[8:11], s78 offen nt lds
    s_mov_b32 s75, 200000
    s_mov_b32 s34, 0
    s_mov_b32 s32, 0x3e0293ee
    s_lshl_b32 s36, s71, 7
    s_add_u32 s36, s36, 345088
    s_getreg_b32 s35, hwreg(HW_REG_XCC_ID)
    s_and_b32 s35, s35, 15
    s_lshl_b32 s24, s71, 18
    s_lshl_b32 s96, s68, 16
    s_add_u32 s24, s24, s96
    s_lshl_b32 s96, s2, 2
    s_add_u32 s96, s96, s68
    s_mul_i32 s76, s96, 20480
    s_and_b32 s76, s76, 0xf000
    s_mov_b32 s26, 0xcccccccc
    s_mov_b32 s27, 0xcccccccc
    s_mov_b32 s28, 0xaaaaaaaa
    s_mov_b32 s29, 0xaaaaaaaa
    s_mov_b32 s12, s54
    s_mov_b32 s13, s55
    s_mov_b32 s14, 67108864
    s_mov_b32 s15, 0x20000
    s_mov_b32 s16, s56
    s_mov_b32 s17, s57
    s_mov_b32 s18, 67108864
    s_mov_b32 s19, 0x20000
    v_and_b32 v8, 15, v0
    v_mov_b32 v9, 0xffff
    v_subrev_u32 v10, 0, v8
    v_lshlrev_b32 v11, 4, v10
    v_lshlrev_b32 v11, v11, v9
    v_cmp_gt_u32 vcc, 2, v10
    s_nop 1
    v_cndmask_b32 v2, 0, v11, vcc
    v_subrev_u32 v10, 2, v8
    v_lshlrev_b32 v11, 4, v10
    v_lshlrev_b32 v11, v11, v9
    v_cmp_gt_u32 vcc, 2, v10
    s_nop 1
    v_cndmask_b32 v3, 0, v11, vcc
    v_subrev_u32 v10, 4, v8
    v_lshlrev_b32 v11, 4, v10
    v_lshlrev_b32 v11, v11, v9
    v_cmp_gt_u32 vcc, 2, v10
    s_nop 1
    v_cndmask_b32 v4, 0, v11, vcc
    v_subrev_u32 v10, 6, v8
    v_lshlrev_b32 v11, 4, v10
    v_lshlrev_b32 v11, v11, v9
    v_cmp_gt_u32 vcc, 2, v10
    s_nop 1
    v_cndmask_b32 v5, 0, v11, vcc
    v_bfe_u32 v10, v0, 3, 1
    v_lshlrev_b32 v10, 9, v10
    v_lshrrev_b32 v11, 4, v0
    v_lshl_add_u32 v10, v11, 7, v10
    v_and_b32 v11, 7, v0
    v_lshl_add_u32 v10, v11, 2, v10
    s_lshl_b32 s96, s68, 10
    s_add_u32 s96, s96, 147456
    v_add_u32 v7, s96, v10
    v_mov_b32 v32, 0
    v_mov_b32 v33, 0
    v_mov_b32 v34, 0
    v_mov_b32 v35, 0
    v_mov_b32_dpp v32, v2 row_shr:8 row_mask:0xf bank_mask:0xc
    v_mov_b32_dpp v33, v3 row_shr:8 row_mask:0xf bank_mask:0xc
    v_mov_b32_dpp v34, v4 row_shr:8 row_mask:0xf bank_mask:0xc
    v_mov_b32_dpp v35, v5 row_shr:8 row_mask:0xf bank_mask:0xc
    v_and_b32 v32, 0x3f803f80, v32
    v_and_b32 v33, 0x3f803f80, v33
    v_and_b32 v34, 0x3f803f80, v34
    v_and_b32 v35, 0x3f803f80, v35
    v_mov_b32 v36, v32
    v_mov_b32 v37, v33
    v_mov_b32 v38, v34
    v_mov_b32 v39, v35
    v_add_u32 v31, 147456, v1
    s_lshl_b32 s78, s68, 3
    s_add_u32 s78, s78, 156160
    v_mov_b32 v30, s78
    s_add_u32 s85, s77, 0
    s_mul_i32 s99, s71, 1024
    s_add_u32 s85, s85, s99
    s_add_u32 s86, s77, 335872
    s_mul_i32 s99, s69, 128
    s_add_u32 s86, s86, s99
    s_mul_i32 s99, s70, 8
    s_add_u32 s86, s86, s99
    s_waitcnt vmcnt(17)
    v_add_u32 v27, s21, v1
    ds_read_b128 v[44:47], v27 offset:0
    ds_read_b128 v[48:51], v27 offset:1024
    ds_read_b128 v[52:55], v27 offset:2048
    ds_read_b128 v[56:59], v27 offset:3072
    ds_read_b128 v[60:63], v27 offset:4096
    v_lshlrev_b32 v6, 16, v6
    v_cvt_pk_bf16_f32 v26, v6, v6
    s_waitcnt lgkmcnt(0)
L_loop:
    v_mov_b32 v28, v6
    v_mul_f32 v29, v6, v6
    v_and_b32_dpp v32, v26, v2 row_newbcast:0 row_mask:0xf bank_mask:0x3
    v_and_b32_dpp v33, v26, v3 row_newbcast:0 row_mask:0xf bank_mask:0x3
    v_and_b32_dpp v34, v26, v4 row_newbcast:0 row_mask:0xf bank_mask:0x3
    v_and_b32_dpp v35, v26, v5 row_newbcast:0 row_mask:0xf bank_mask:0x3
    v_and_b32_dpp v36, v26, v2 row_newbcast:1 row_mask:0xf bank_mask:0x3
    v_and_b32_dpp v37, v26, v3 row_newbcast:1 row_mask:0xf bank_mask:0x3
    v_and_b32_dpp v38, v26, v4 row_newbcast:1 row_mask:0xf bank_mask:0x3
    v_and_b32_dpp v39, v26, v5 row_newbcast:1 row_mask:0xf bank_mask:0x3
    v_mfma_f32_16x16x32_bf16 v[40:43], v[44:47], v[32:35], 0
    v_add_f32_dpp v28, v28, v28 row_ror:8 row_mask:0xf bank_mask:0xf
    v_add_f32_dpp v29, v29, v29 row_ror:8 row_mask:0xf bank_mask:0xf
    s_nop 0
    v_and_b32_dpp v32, v26, v2 row_newbcast:2 row_mask:0xf bank_mask:0x3
    v_and_b32_dpp v33, v26, v3 row_newbcast:2 row_mask:0xf bank_mask:0x3
    v_and_b32_dpp v34, v26, v4 row_newbcast:2 row_mask:0xf bank_mask:0x3
    v_and_b32_dpp v35, v26, v5 row_newbcast:2 row_mask:0xf bank_mask:0x3
    v_mfma_f32_16x16x32_bf16 v[40:43], v[48:51], v[36:39], v[40:43]
    v_add_f32_dpp v28, v28, v28 row_ror:4 row_mask:0xf bank_mask:0xf
    v_add_f32_dpp v29, v29, v29 row_ror:4 row_mask:0xf bank_mask:0xf
    s_nop 0
    v_and_b32_dpp v36, v26, v2 row_newbcast:3 row_mask:0xf bank_mask:0x3
    v_and_b32_dpp v37, v26, v3 row_newbcast:3 row_mask:0xf bank_mask:0x3
    v_and_b32_dpp v38, v26, v4 row_newbcast:3 row_mask:0xf bank_mask:0x3
    v_and_b32_dpp v39, v26, v5 row_newbcast:3 row_mask:0xf bank_mask:0x3
    v_mfma_f32_16x16x32_bf16 v[40:43], v[52:55], v[32:35], v[40:43]
    v_add_f32_dpp v28, v28, v28 row_ror:2 row_mask:0xf bank_mask:0xf
    v_add_f32_dpp v29, v29, v29 row_ror:2 row_mask:0xf bank_mask:0xf
    s_nop 0
    v_and_b32_dpp v32, v26, v2 row_newbcast:4 row_mask:0xf bank_mask:0x3
    v_and_b32_dpp v33, v26, v3 row_newbcast:4 row_mask:0xf bank_mask:0x3
    v_and_b32_dpp v34, v26, v4 row_newbcast:4 row_mask:0xf bank_mask:0x3
    v_and_b32_dpp v35, v26, v5 row_newbcast:4 row_mask:0xf bank_mask:0x3
    v_mfma_f32_16x16x32_bf16 v[40:43], v[56:59], v[36:39], v[40:43]
    v_add_f32_dpp v28, v28, v28 row_ror:1 row_mask:0xf bank_mask:0xf
    v_add_f32_dpp v29, v29, v29 row_ror:1 row_mask:0xf bank_mask:0xf
    s_nop 0
    v_add_f32_dpp v28, v28, v28 row_bcast:15 row_mask:0xa bank_mask:0xf
    v_add_f32_dpp v29, v29, v29 row_bcast:15 row_mask:0xa bank_mask:0xf
    v_mfma_f32_16x16x32_bf16 v[40:43], v[60:63], v[32:35], v[40:43]
    s_nop 0
    v_add_f32_dpp v28, v28, v28 row_bcast:31 row_mask:0xc bank_mask:0xf
    v_add_f32_dpp v29, v29, v29 row_bcast:31 row_mask:0xc bank_mask:0xf
    s_mov_b32 exec_lo, 0
    s_mov_b32 exec_hi, 0x80000000
    ds_write_b64 v30, v[28:29]
    s_mov_b64 exec, -1
    s_nop 0
    ds_write_b32 v7, v40 offset:0
    ds_write_b32 v7, v41 offset:32
    ds_write_b32 v7, v42 offset:64
    ds_write_b32 v7, v43 offset:96
    s_cmp_eq_u32 s74, 0
    s_cbranch_scc1 L_nit0_3
    s_cmp_lg_u32 s68, 0
    s_cbranch_scc1 L_nit0_3
    s_mov_b32 s8, s64
    s_mov_b32 s9, s65
    s_mov_b32 s10, 256
    s_mov_b32 s11, 0x20000
L_flagspin_4:
    buffer_load_dword v63, off, s[8:11], 0 sc1
    s_waitcnt vmcnt(0)
    v_cmp_eq_u32 vcc, -1, v63
    s_nop 3
    s_cbranch_vccnz L_flagok_5
    s_sub_u32 s75, s75, 1
    s_cbranch_scc0 L_flagspin_4
    s_mov_b32 s75, 0
L_flagok_5:
L_nit0_3:
    s_waitcnt lgkmcnt(0)
    s_barrier
    s_cmp_lg_u32 s68, 0
    s_cbranch_scc1 L_nw0_6
    ds_read_b128 v[8:11], v31 offset:0
    ds_read_b128 v[12:15], v31 offset:1024
    ds_read_b128 v[16:19], v31 offset:2048
    ds_read_b128 v[20:23], v31 offset:3072
    v_mov_b32 v30, 156160
    ds_read_b128 v[32:35], v30
    ds_read_b128 v[36:39], v30 offset:16
    s_waitcnt lgkmcnt(4)
    v_pk_add_f32 v[8:9], v[8:9], v[12:13]
    v_pk_add_f32 v[10:11], v[10:11], v[14:15]
    s_waitcnt lgkmcnt(2)
    v_pk_add_f32 v[16:17], v[16:17], v[20:21]
    v_pk_add_f32 v[18:19], v[18:19], v[22:23]
    v_pk_add_f32 v[8:9], v[8:9], v[16:17]
    v_pk_add_f32 v[10:11], v[10:11], v[18:19]
    s_waitcnt lgkmcnt(0)
    v_pk_add_f32 v[32:33], v[32:33], v[34:35]
    v_pk_add_f32 v[36:37], v[36:37], v[38:39]
    v_pk_add_f32 v[32:33], v[32:33], v[36:37]
    s_cmp_eq_u32 s34, 0
    s_cbranch_scc1 L_gst_7
    buffer_store_dwordx4 v[8:11], v1, s[4:7], s85 offen
    s_mov_b64 exec, 1
    buffer_store_dwordx2 v[32:33], off, s[4:7], s86
    s_mov_b64 exec, -1
    s_branch L_gste_8
L_gst_7:
    buffer_store_dwordx4 v[8:11], v1, s[4:7], s85 offen sc1
    s_mov_b64 exec, 1
    buffer_store_dwordx2 v[32:33], off, s[4:7], s86 sc1
    s_mov_b64 exec, -1
L_gste_8:
    s_cmp_eq_u32 s74, 0
    s_cbranch_scc1 L_nit0_9
    s_mov_b32 s78, 344064
    s_mul_i32 s99, s71, 4
    s_add_u32 s78, s78, s99
    v_mov_b32 v12, s35
    s_mov_b64 exec, 1
    buffer_store_dword v12, off, s[4:7], s78 sc1
    s_mov_b64 exec, -1
L_nit0_9:
L_nw0_6:
    s_add_u32 s81, s77, 0
    s_mul_i32 s99, s69, 8192
    s_add_u32 s81, s81, s99
    s_add_u32 s82, s81, 4096
    s_add_u32 s83, s77, 335872
    s_mul_i32 s99, s69, 128
    s_add_u32 s83, s83, s99
    s_mov_b32 s84, 344064
    s_mul_i32 s99, s69, 32
    s_add_u32 s84, s84, s99
    v_and_b32 v42, 7, v0
    v_lshlrev_b32 v60, 2, v42
    v_lshlrev_b32 v42, 3, v42
    v_lshlrev_b32 v61, 3, v0
    v_add_u32 v61, 155648, v61
    v_and_b32 v62, 0xf0, v1
    v_add_u32 v62, 155648, v62
    s_cmp_eq_u32 s34, 0
    s_cbranch_scc1 L_gack_10
    s_waitcnt vmcnt(2)
    s_branch L_gack2_11
L_gack_10:
    s_waitcnt vmcnt(0)
L_gack2_11:
    s_add_u32 s85, s77, 262144
    s_mul_i32 s99, s73, 16384
    s_add_u32 s85, s85, s99
    s_lshr_b32 s78, s70, 1
    s_lshl_b32 s78, s78, 12
    s_add_u32 s85, s85, s78
    s_and_b32 s78, s70, 1
    s_lshl_b32 s78, s78, 11
    s_add_u32 s85, s85, s78
    s_lshr_b32 s78, s68, 1
    s_lshl_b32 s78, s78, 10
    s_add_u32 s85, s85, s78
    s_and_b32 s78, s68, 1
    s_lshl_b32 s78, s78, 9
    s_add_u32 s85, s85, s78
    s_and_b32 s78, s69, 15
    s_lshl_b32 s78, s78, 4
    s_add_u32 s85, s85, s78
    s_cmp_eq_u32 s68, 0
    s_cbranch_scc1 L_w0poll_13
    v_add_u32 v63, s22, v1
    ds_read_b128 v[44:47], v63 offset:0
    ds_read_b128 v[48:51], v63 offset:1024
    ds_read_b128 v[52:55], v63 offset:2048
    ds_read_b128 v[56:59], v63 offset:3072
    s_cmp_eq_u32 s74, 0
    s_cbranch_scc1 L_nit0_14
    s_add_u32 s78, s76, 0
    s_and_b32 s78, s78, 0xffff
    s_add_u32 s78, s78, s24
    buffer_load_dwordx4 v[64:67], v1, s[12:15], s78 offen offset:0 nt
    buffer_load_dwordx4 v[68:71], v1, s[12:15], s78 offen offset:1024 nt
    buffer_load_dwordx4 v[72:75], v1, s[12:15], s78 offen offset:2048 nt
    buffer_load_dwordx4 v[76:79], v1, s[12:15], s78 offen offset:3072 nt
    s_add_u32 s78, s76, 4096
    s_and_b32 s78, s78, 0xffff
    s_add_u32 s78, s78, s24
    buffer_load_dwordx4 v[80:83], v1, s[12:15], s78 offen offset:0 nt
    buffer_load_dwordx4 v[84:87], v1, s[12:15], s78 offen offset:1024 nt
    buffer_load_dwordx4 v[88:91], v1, s[12:15], s78 offen offset:2048 nt
    buffer_load_dwordx4 v[92:95], v1, s[12:15], s78 offen offset:3072 nt
    s_add_u32 s78, s76, 8192
    s_and_b32 s78, s78, 0xffff
    s_add_u32 s78, s78, s24
    buffer_load_dwordx4 v[96:99], v1, s[12:15], s78 offen offset:0 nt
    buffer_load_dwordx4 v[100:103], v1, s[12:15], s78 offen offset:1024 nt
L_nit0_14:
    s_branch L_nopoll_12
L_w0poll_13:
    buffer_load_dwordx4 v[8:11], v1, s[4:7], s81 offen offset:0 sc1
    buffer_load_dwordx4 v[12:15], v1, s[4:7], s81 offen offset:1024 sc1
    buffer_load_dwordx4 v[16:19], v1, s[4:7], s81 offen offset:2048 sc1
    buffer_load_dwordx4 v[20:23], v1, s[4:7], s81 offen offset:3072 sc1
    buffer_load_dwordx4 v[24:27], v1, s[4:7], s82 offen offset:0 sc1
    buffer_load_dwordx4 v[28:31], v1, s[4:7], s82 offen offset:1024 sc1
    buffer_load_dwordx4 v[32:35], v1, s[4:7], s82 offen offset:2048 sc1
    buffer_load_dwordx4 v[36:39], v1, s[4:7], s82 offen offset:3072 sc1
    buffer_load_dwordx2 v[40:41], v42, s[4:7], s83 offen sc1
    buffer_load_dword v43, v60, s[4:7], s84 offen sc1
    v_add_u32 v63, s22, v1
    ds_read_b128 v[44:47], v63 offset:0
    ds_read_b128 v[48:51], v63 offset:1024
    ds_read_b128 v[52:55], v63 offset:2048
    ds_read_b128 v[56:59], v63 offset:3072
    s_cmp_eq_u32 s74, 0
    s_cbranch_scc1 L_nit0_18
    s_add_u32 s78, s76, 0
    s_and_b32 s78, s78, 0xffff
    s_add_u32 s78, s78, s24
    buffer_load_dwordx4 v[64:67], v1, s[12:15], s78 offen offset:0 nt
    buffer_load_dwordx4 v[68:71], v1, s[12:15], s78 offen offset:1024 nt
    buffer_load_dwordx4 v[72:75], v1, s[12:15], s78 offen offset:2048 nt
    buffer_load_dwordx4 v[76:79], v1, s[12:15], s78 offen offset:3072 nt
    s_add_u32 s78, s76, 4096
    s_and_b32 s78, s78, 0xffff
    s_add_u32 s78, s78, s24
    buffer_load_dwordx4 v[80:83], v1, s[12:15], s78 offen offset:0 nt
    buffer_load_dwordx4 v[84:87], v1, s[12:15], s78 offen offset:1024 nt
    buffer_load_dwordx4 v[88:91], v1, s[12:15], s78 offen offset:2048 nt
    buffer_load_dwordx4 v[92:95], v1, s[12:15], s78 offen offset:3072 nt
    s_add_u32 s78, s76, 8192
    s_and_b32 s78, s78, 0xffff
    s_add_u32 s78, s78, s24
    buffer_load_dwordx4 v[96:99], v1, s[12:15], s78 offen offset:0 nt
    buffer_load_dwordx4 v[100:103], v1, s[12:15], s78 offen offset:1024 nt
    s_waitcnt vmcnt(10)
    s_branch L_chk_16_b
L_nit0_18:
    s_branch L_chk_16
L_retry_15:
    s_sub_u32 s75, s75, 1
    s_cbranch_scc0 L_retry_15_go
    s_mov_b32 s75, 0
    s_branch L_done_17
L_retry_15_go:
    buffer_load_dwordx4 v[8:11], v1, s[4:7], s81 offen offset:0 sc1
    buffer_load_dwordx4 v[12:15], v1, s[4:7], s81 offen offset:1024 sc1
    buffer_load_dwordx4 v[16:19], v1, s[4:7], s81 offen offset:2048 sc1
    buffer_load_dwordx4 v[20:23], v1, s[4:7], s81 offen offset:3072 sc1
    buffer_load_dwordx4 v[24:27], v1, s[4:7], s82 offen offset:0 sc1
    buffer_load_dwordx4 v[28:31], v1, s[4:7], s82 offen offset:1024 sc1
    buffer_load_dwordx4 v[32:35], v1, s[4:7], s82 offen offset:2048 sc1
    buffer_load_dwordx4 v[36:39], v1, s[4:7], s82 offen offset:3072 sc1
    buffer_load_dwordx2 v[40:41], v42, s[4:7], s83 offen sc1
    buffer_load_dword v43, v60, s[4:7], s84 offen sc1
L_chk_16:
    s_waitcnt vmcnt(0)
L_chk_16_b:
    v_pk_add_f32 v[8:9], v[8:9], v[24:25]
    v_pk_add_f32 v[10:11], v[10:11], v[26:27]
    v_pk_add_f32 v[12:13], v[12:13], v[28:29]
    v_pk_add_f32 v[14:15], v[14:15], v[30:31]
    v_pk_add_f32 v[16:17], v[16:17], v[32:33]
    v_pk_add_f32 v[18:19], v[18:19], v[34:35]
    v_pk_add_f32 v[20:21], v[20:21], v[36:37]
    v_pk_add_f32 v[22:23], v[22:23], v[38:39]
    v_pk_add_f32 v[8:9], v[8:9], v[16:17]
    v_pk_add_f32 v[10:11], v[10:11], v[18:19]
    v_pk_add_f32 v[12:13], v[12:13], v[20:21]
    v_pk_add_f32 v[14:15], v[14:15], v[22:23]
    v_pk_add_f32 v[8:9], v[8:9], v[12:13]
    v_pk_add_f32 v[10:11], v[10:11], v[14:15]
    v_add_f32 v12, v8, v9
    v_add_f32 v13, v10, v11
    v_add_f32 v14, v40, v41
    v_add_f32 v12, v12, v13
    v_add_f32 v12, v12, v14
    v_cmp_u_f32 vcc, v12, v12
    v_cmp_eq_u32 s[90:91], -1, v43
    s_nop 1
    s_or_b64 vcc, vcc, s[90:91]
    s_nop 0
    s_cbranch_vccnz L_retry_15
L_done_17:
    v_cmp_ne_u32 vcc, s35, v43
    s_nop 1
    s_cmp_eq_u64 vcc, 0
    s_cselect_b32 s34, 1, 0
    v_add_f32_dpp v40, v40, v40 quad_perm:[1,0,3,2] row_mask:0xf bank_mask:0xf
    v_add_f32_dpp v41, v41, v41 quad_perm:[1,0,3,2] row_mask:0xf bank_mask:0xf
    s_nop 0
    v_add_f32_dpp v40, v40, v40 quad_perm:[2,3,0,1] row_mask:0xf bank_mask:0xf
    v_add_f32_dpp v41, v41, v41 quad_perm:[2,3,0,1] row_mask:0xf bank_mask:0xf
    s_nop 0
    v_add_f32_dpp v40, v40, v40 row_half_mirror row_mask:0xf bank_mask:0xf
    v_add_f32_dpp v41, v41, v41 row_half_mirror row_mask:0xf bank_mask:0xf
    v_mul_f32 v40, 0x3acccccd, v40
    v_mul_f32 v41, 0x3acccccd, v41
    v_fma_f32 v41, -v40, v40, v41
    v_add_f32 v41, 0x3727c5ac, v41
    v_rsq_f32 v41, v41
    v_permlane32_swap_b32 v8, v12
    v_permlane32_swap_b32 v9, v13
    v_permlane32_swap_b32 v10, v14
    v_permlane32_swap_b32 v11, v15
    v_fma_f32 v8, -v40, v12, v8
    v_fma_f32 v9, -v40, v13, v9
    v_fma_f32 v10, -v40, v14, v10
    v_fma_f32 v11, -v40, v15, v11
    v_pk_mul_f32 v[8:9], v[8:9], v[40:41] op_sel:[0,1] op_sel_hi:[1,1]
    v_pk_mul_f32 v[10:11], v[10:11], v[40:41] op_sel:[0,1] op_sel_hi:[1,1]
    v_cvt_pk_bf16_f32 v12, v8, v9
    v_cvt_pk_bf16_f32 v13, v10, v11
    ds_write_b64 v61, v[12:13]
    s_waitcnt lgkmcnt(0)
L_nopoll_12:
    s_barrier
    ds_read_b128 v[8:11], v62
    v_lshrrev_b32 v39, 3, v0
    v_lshrrev_b32 v38, 2, v39
    v_and_b32 v39, 3, v39
    v_lshlrev_b32 v39, 2, v39
    v_lshl_add_u32 v39, v38, 8, v39
    s_waitcnt lgkmcnt(0)
    v_dot2_f32_bf16 v32, v44, v8, 0
    v_dot2_f32_bf16 v33, v48, v8, 0
    v_dot2_f32_bf16 v34, v52, v8, 0
    v_dot2_f32_bf16 v35, v56, v8, 0
    v_dot2c_f32_bf16 v32, v45, v9
    v_dot2c_f32_bf16 v33, v49, v9
    v_dot2c_f32_bf16 v34, v53, v9
    v_dot2c_f32_bf16 v35, v57, v9
    v_dot2c_f32_bf16 v32, v46, v10
    v_dot2c_f32_bf16 v33, v50, v10
    v_dot2c_f32_bf16 v34, v54, v10
    v_dot2c_f32_bf16 v35, v58, v10
    v_dot2c_f32_bf16 v32, v47, v11
    v_dot2c_f32_bf16 v33, v51, v11
    v_dot2c_f32_bf16 v34, v55, v11
    v_dot2c_f32_bf16 v35, v59, v11
    v_add_f32_dpp v36, v32, v32 row_ror:8 row_mask:0xf bank_mask:0x3
    v_add_f32_dpp v37, v33, v33 row_ror:8 row_mask:0xf bank_mask:0x3
    s_nop 0
    v_add_f32_dpp v36, v34, v34 row_ror:8 row_mask:0xf bank_mask:0xc
    v_add_f32_dpp v37, v35, v35 row_ror:8 row_mask:0xf bank_mask:0xc
    s_nop 0
    v_add_f32_dpp v38, v36, v36 row_shl:4 row_mask:0xf bank_mask:0x5
    s_nop 1
    v_add_f32_dpp v38, v37, v37 row_shr:4 row_mask:0xf bank_mask:0xa
    s_nop 1
    v_add_f32_dpp v38, v38, v38 quad_perm:[2,3,0,1] row_mask:0xf bank_mask:0xf
    s_nop 1
    v_add_f32_dpp v38, v38, v38 quad_perm:[1,0,3,2] row_mask:0xf bank_mask:0xf
    v_mul_f32 v38, s32, v38
    s_nop 1
    v_mov_b32_dpp v37, v38 row_shl:4 row_mask:0xf bank_mask:0x5
    v_cvt_pk_bf16_f32 v38, v38, v37
    s_mov_b32 exec_lo, 0x01010101
    s_mov_b32 exec_hi, 0x01010101
    buffer_store_dword v38, v39, s[4:7], s85 offen sc1
    s_mov_b64 exec, -1
    s_mov_b32 s8, s48
    s_mov_b32 s9, s49
    s_mov_b32 s10, 4194304
    s_mov_b32 s11, 0x20000
    s_mul_i32 s79, s70, 524288
    s_mul_i32 s99, s68, 131072
    s_add_u32 s79, s79, s99
    s_mul_i32 s99, s69, 256
    s_add_u32 s79, s79, s99
    v_lshrrev_b32 v62, 4, v0
    s_mov_b32 s99, 8192
    v_mul_lo_u32 v62, v62, s99
    v_and_b32 v63, 0xf0, v1
    v_add_u32 v62, v62, v63
    s_add_u32 m0, s22, 0
    s_add_u32 s78, s79, 0
    buffer_load_dwordx4 v62, s[8:11], s78 offen nt lds
    s_add_u32 m0, s22, 1024
    s_add_u32 s78, s79, 32768
    buffer_load_dwordx4 v62, s[8:11], s78 offen nt lds
    s_add_u32 m0, s22, 2048
    s_add_u32 s78, s79, 65536
    buffer_load_dwordx4 v62, s[8:11], s78 offen nt lds
    s_add_u32 m0, s22, 3072
    s_add_u32 s78, s79, 98304
    buffer_load_dwordx4 v62, s[8:11], s78 offen nt lds
    s_cmp_eq_u32 s74, 0
    s_cbranch_scc1 L_nit0_19
    s_mov_b32 s8, s42
    s_mov_b32 s9, s43
    s_mov_b32 s10, 8388608
    s_mov_b32 s11, 0x20000
    s_mul_i32 s79, s72, 65536
    s_mul_i32 s99, s68, 256
    s_add_u32 s79, s79, s99
    v_lshrrev_b32 v16, 4, v0
    v_and_b32 v17, 15, v0
    v_add_u32 v22, 0, v16
    v_and_b32 v23, 1, v22
    v_and_b32 v18, 6, v22
    v_lshl_or_b32 v23, v18, 1, v23
    v_bfe_u32 v18, v22, 3, 1
    v_lshl_or_b32 v23, v18, 1, v23
    v_xor_b32 v23, v23, v17
    v_lshlrev_b32 v23, 4, v23
    v_lshl_add_u32 v18, v16, 10, v23
    v_add_u32 v22, 4, v16
    v_and_b32 v23, 1, v22
    v_and_b32 v19, 6, v22
    v_lshl_or_b32 v23, v19, 1, v23
    v_bfe_u32 v19, v22, 3, 1
    v_lshl_or_b32 v23, v19, 1, v23
    v_xor_b32 v23, v23, v17
    v_lshlrev_b32 v23, 4, v23
    v_lshl_add_u32 v19, v16, 10, v23
    v_add_u32 v22, 8, v16
    v_and_b32 v23, 1, v22
    v_and_b32 v20, 6, v22
    v_lshl_or_b32 v23, v20, 1, v23
    v_bfe_u32 v20, v22, 3, 1
    v_lshl_or_b32 v23, v20, 1, v23
    v_xor_b32 v23, v23, v17
    v_lshlrev_b32 v23, 4, v23
    v_lshl_add_u32 v20, v16, 10, v23
    v_add_u32 v22, 12, v16
    v_and_b32 v23, 1, v22
    v_and_b32 v21, 6, v22
    v_lshl_or_b32 v23, v21, 1, v23
    v_bfe_u32 v21, v22, 3, 1
    v_lshl_or_b32 v23, v21, 1, v23
    v_xor_b32 v23, v23, v17
    v_lshlrev_b32 v23, 4, v23
    v_lshl_add_u32 v21, v16, 10, v23
    s_add_u32 m0, s21, 0
    s_add_u32 s78, s79, 32768
    buffer_load_dwordx4 v18, s[8:11], s78 offen nt lds
    s_add_u32 m0, s21, 1024
    s_add_u32 s78, s79, 36864
    buffer_load_dwordx4 v19, s[8:11], s78 offen nt lds
    s_add_u32 m0, s21, 2048
    s_add_u32 s78, s79, 40960
    buffer_load_dwordx4 v20, s[8:11], s78 offen nt lds
    s_add_u32 m0, s21, 3072
    s_add_u32 s78, s79, 45056
    buffer_load_dwordx4 v21, s[8:11], s78 offen nt lds
    s_add_u32 m0, s21, 4096
    s_add_u32 s78, s79, 49152
    buffer_load_dwordx4 v18, s[8:11], s78 offen nt lds
    s_add_u32 m0, s21, 5120
    s_add_u32 s78, s79, 53248
    buffer_load_dwordx4 v19, s[8:11], s78 offen nt lds
    s_add_u32 m0, s21, 6144
    s_add_u32 s78, s79, 57344
    buffer_load_dwordx4 v20, s[8:11], s78 offen nt lds
    s_add_u32 m0, s21, 7168
    s_add_u32 s78, s79, 61440
    buffer_load_dwordx4 v21, s[8:11], s78 offen nt lds
L_nit0_19:
    s_add_u32 s81, s77, 262144
    s_mul_i32 s99, s73, 16384
    s_add_u32 s81, s81, s99
    s_mul_i32 s99, s68, 4096
    s_add_u32 s81, s81, s99
    v_and_b32 v60, 15, v0
    v_lshlrev_b32 v61, 10, v60
    v_lshrrev_b32 v62, 4, v0
    v_lshl_add_u32 v24, v62, 4, v61
    v_and_b32 v61, 1, v60
    v_and_b32 v63, 6, v60
    v_lshl_or_b32 v61, v63, 1, v61
    v_bfe_u32 v63, v60, 3, 1
    v_lshl_or_b32 v61, v63, 1, v61
    v_lshlrev_b32 v60, 8, v60
    v_add_u32 v60, s20, v60
    v_add_u32 v63, 0, v62
    v_xor_b32 v63, v63, v61
    v_lshl_add_u32 v56, v63, 4, v60
    v_add_u32 v63, 4, v62
    v_xor_b32 v63, v63, v61
    v_lshl_add_u32 v57, v63, 4, v60
    v_add_u32 v63, 8, v62
    v_xor_b32 v63, v63, v61
    v_lshl_add_u32 v58, v63, 4, v60
    v_add_u32 v63, 12, v62
    v_xor_b32 v63, v63, v61
    v_lshl_add_u32 v59, v63, 4, v60
    s_add_u32 s82, s77, 655360
    s_mul_i32 s99, s71, 16384
    s_add_u32 s82, s82, s99
    s_mul_i32 s99, s68, 256
    s_add_u32 s82, s82, s99
    s_add_u32 s83, s77, 393216
    s_mul_i32 s99, s73, 65536
    s_add_u32 s83, s83, s99
    s_mul_i32 s99, s68, 16384
    s_add_u32 s83, s83, s99
    s_mul_i32 s99, s72, 8
    s_add_u32 s83, s83, s99
    s_waitcnt vmcnt(0)
    buffer_load_dwordx4 v[8:11], v1, s[4:7], s81 offen offset:0 sc1
    buffer_load_dwordx4 v[12:15], v1, s[4:7], s81 offen offset:1024 sc1
    buffer_load_dwordx4 v[16:19], v1, s[4:7], s81 offen offset:2048 sc1
    buffer_load_dwordx4 v[20:23], v1, s[4:7], s81 offen offset:3072 sc1
    ds_read_b128 v[40:43], v56 offset:0
    ds_read_b128 v[44:47], v57 offset:0
    ds_read_b128 v[48:51], v58 offset:0
    ds_read_b128 v[52:55], v59 offset:0
    s_add_u32 s78, s68, 0
    s_and_b32 s78, s78, 3
    s_lshl_b32 s78, s78, 12
    s_add_u32 s78, s78, 147456
    v_add_u32 v60, s78, v1
    s_add_u32 s78, s68, 1
    s_and_b32 s78, s78, 3
    s_lshl_b32 s78, s78, 12
    s_add_u32 s78, s78, 147456
    v_add_u32 v61, s78, v1
    s_add_u32 s78, s68, 2
    s_and_b32 s78, s78, 3
    s_lshl_b32 s78, s78, 12
    s_add_u32 s78, s78, 147456
    v_add_u32 v62, s78, v1
    s_add_u32 s78, s68, 3
    s_and_b32 s78, s78, 3
    s_lshl_b32 s78, s78, 12
    s_add_u32 s78, s78, 147456
    v_add_u32 v63, s78, v1
    s_nop 0
    s_branch L_chk_21
L_retry_20:
    s_sub_u32 s75, s75, 1
    s_cbranch_scc0 L_retry_20_go
    s_mov_b32 s75, 0
    s_branch L_done_22
L_retry_20_go:
    buffer_load_dwordx4 v[8:11], v1, s[4:7], s81 offen offset:0 sc1
    buffer_load_dwordx4 v[12:15], v1, s[4:7], s81 offen offset:1024 sc1
    buffer_load_dwordx4 v[16:19], v1, s[4:7], s81 offen offset:2048 sc1
    buffer_load_dwordx4 v[20:23], v1, s[4:7], s81 offen offset:3072 sc1
L_chk_21:
    s_waitcnt vmcnt(0)
    v_max3_u32 v25, v8, v9, v10
    v_max3_u32 v25, v25, v11, v12
    v_max3_u32 v25, v25, v13, v14
    v_max3_u32 v25, v25, v15, v16
    v_max3_u32 v25, v25, v17, v18
    v_max3_u32 v25, v25, v19, v20
    v_max3_u32 v25, v25, v21, v22
    v_max_u32 v25, v25, v23
    v_cmp_eq_u32 vcc, -1, v25
    s_nop 3
    s_cbranch_vccnz L_retry_20
L_done_22:
    s_waitcnt lgkmcnt(3)
    v_mfma_f32_16x16x32_bf16 v[24:27], v[40:43], v[8:11], 0
    ds_read_b128 v[40:43], v56 offset:4096
    s_waitcnt lgkmcnt(3)
    v_mfma_f32_16x16x32_bf16 v[24:27], v[44:47], v[12:15], v[24:27]
    ds_read_b128 v[44:47], v57 offset:4096
    s_waitcnt lgkmcnt(3)
    v_mfma_f32_16x16x32_bf16 v[24:27], v[48:51], v[16:19], v[24:27]
    ds_read_b128 v[48:51], v58 offset:4096
    s_waitcnt lgkmcnt(3)
    v_mfma_f32_16x16x32_bf16 v[24:27], v[52:55], v[20:23], v[24:27]
    ds_read_b128 v[52:55], v59 offset:4096
    s_waitcnt lgkmcnt(3)
    v_mfma_f32_16x16x32_bf16 v[28:31], v[40:43], v[8:11], 0
    ds_read_b128 v[40:43], v56 offset:32768
    s_waitcnt lgkmcnt(3)
    v_mfma_f32_16x16x32_bf16 v[28:31], v[44:47], v[12:15], v[28:31]
    ds_read_b128 v[44:47], v57 offset:32768
    s_waitcnt lgkmcnt(3)
    v_mfma_f32_16x16x32_bf16 v[28:31], v[48:51], v[16:19], v[28:31]
    ds_read_b128 v[48:51], v58 offset:32768
    s_waitcnt lgkmcnt(3)
    v_mfma_f32_16x16x32_bf16 v[28:31], v[52:55], v[20:23], v[28:31]
    ds_read_b128 v[52:55], v59 offset:32768
    s_waitcnt lgkmcnt(3)
    v_mfma_f32_16x16x32_bf16 v[32:35], v[40:43], v[8:11], 0
    ds_read_b128 v[40:43], v56 offset:36864
    s_waitcnt lgkmcnt(3)
    v_mfma_f32_16x16x32_bf16 v[32:35], v[44:47], v[12:15], v[32:35]
    ds_read_b128 v[44:47], v57 offset:36864
    s_waitcnt lgkmcnt(3)
    v_mfma_f32_16x16x32_bf16 v[32:35], v[48:51], v[16:19], v[32:35]
    ds_read_b128 v[48:51], v58 offset:36864
    s_waitcnt lgkmcnt(3)
    v_mfma_f32_16x16x32_bf16 v[32:35], v[52:55], v[20:23], v[32:35]
    ds_read_b128 v[52:55], v59 offset:36864
    s_waitcnt lgkmcnt(3)
    v_mfma_f32_16x16x32_bf16 v[36:39], v[40:43], v[8:11], 0
    s_waitcnt lgkmcnt(2)
    v_mfma_f32_16x16x32_bf16 v[36:39], v[44:47], v[12:15], v[36:39]
    s_waitcnt lgkmcnt(1)
    v_mfma_f32_16x16x32_bf16 v[36:39], v[48:51], v[16:19], v[36:39]
    s_waitcnt lgkmcnt(0)
    v_mfma_f32_16x16x32_bf16 v[36:39], v[52:55], v[20:23], v[36:39]
    ds_write_b128 v60, v[24:27] offset:0
    ds_write_b128 v60, v[28:31] offset:1024
    ds_write_b128 v60, v[32:35] offset:2048
    s_nop 4
    ds_write_b128 v60, v[36:39] offset:3072
    v_lshrrev_b32 v8, 2, v0
    v_and_b32 v9, 1, v8
    v_and_b32 v10, 6, v8
    v_lshl_or_b32 v9, v10, 1, v9
    v_bfe_u32 v10, v8, 3, 1
    v_lshl_or_b32 v9, v10, 1, v9
    v_and_b32 v10, 3, v0
    v_lshlrev_b32 v8, 8, v8
    v_add_u32 v8, s20, v8
    v_add_u32 v11, 0, v10
    v_xor_b32 v11, v11, v9
    v_lshl_add_u32 v56, v11, 4, v8
    v_add_u32 v11, 4, v10
    v_xor_b32 v11, v11, v9
    v_lshl_add_u32 v57, v11, 4, v8
    v_add_u32 v11, 8, v10
    v_xor_b32 v11, v11, v9
    v_lshl_add_u32 v58, v11, 4, v8
    v_add_u32 v11, 12, v10
    v_xor_b32 v11, v11, v9
    v_lshl_add_u32 v59, v11, 4, v8
    s_waitcnt lgkmcnt(0)
    s_barrier
    ds_read_b128 v[8:11], v61 offset:0
    ds_read_b128 v[12:15], v61 offset:1024
    ds_read_b128 v[16:19], v61 offset:2048
    ds_read_b128 v[20:23], v61 offset:3072
    ds_read_b128 v[40:43], v62 offset:0
    ds_read_b128 v[44:47], v62 offset:1024
    ds_read_b128 v[48:51], v62 offset:2048
    ds_read_b128 v[52:55], v62 offset:3072
    s_waitcnt lgkmcnt(4)
    v_pk_add_f32 v[24:25], v[24:25], v[8:9]
    v_pk_add_f32 v[26:27], v[26:27], v[10:11]
    v_pk_add_f32 v[28:29], v[28:29], v[12:13]
    v_pk_add_f32 v[30:31], v[30:31], v[14:15]
    v_pk_add_f32 v[32:33], v[32:33], v[16:17]
    v_pk_add_f32 v[34:35], v[34:35], v[18:19]
    v_pk_add_f32 v[36:37], v[36:37], v[20:21]
    v_pk_add_f32 v[38:39], v[38:39], v[22:23]
    ds_read_b128 v[8:11], v63 offset:0
    ds_read_b128 v[12:15], v63 offset:1024
    ds_read_b128 v[16:19], v63 offset:2048
    ds_read_b128 v[20:23], v63 offset:3072
    s_waitcnt lgkmcnt(4)
    v_pk_add_f32 v[24:25], v[24:25], v[40:41]
    v_pk_add_f32 v[26:27], v[26:27], v[42:43]
    v_pk_add_f32 v[28:29], v[28:29], v[44:45]
    v_pk_add_f32 v[30:31], v[30:31], v[46:47]
    v_pk_add_f32 v[32:33], v[32:33], v[48:49]
    v_pk_add_f32 v[34:35], v[34:35], v[50:51]
    v_pk_add_f32 v[36:37], v[36:37], v[52:53]
    v_pk_add_f32 v[38:39], v[38:39], v[54:55]
    ds_read_b64_tr_b16 v[40:41], v56 offset:0
    ds_read_b64_tr_b16 v[42:43], v56 offset:4096
    ds_read_b64_tr_b16 v[44:45], v56 offset:32768
    ds_read_b64_tr_b16 v[46:47], v56 offset:36864
    ds_read_b64_tr_b16 v[48:49], v56 offset:8
    ds_read_b64_tr_b16 v[50:51], v56 offset:4104
    ds_read_b64_tr_b16 v[52:53], v56 offset:32776
    ds_read_b64_tr_b16 v[54:55], v56 offset:36872
    s_waitcnt lgkmcnt(8)
    v_pk_add_f32 v[24:25], v[24:25], v[8:9]
    v_pk_add_f32 v[26:27], v[26:27], v[10:11]
    v_pk_add_f32 v[28:29], v[28:29], v[12:13]
    v_pk_add_f32 v[30:31], v[30:31], v[14:15]
    v_pk_add_f32 v[32:33], v[32:33], v[16:17]
    v_pk_add_f32 v[34:35], v[34:35], v[18:19]
    v_pk_add_f32 v[36:37], v[36:37], v[20:21]
    v_pk_add_f32 v[38:39], v[38:39], v[22:23]
    v_max3_f32 v8, v24, v25, v26
    v_max3_f32 v8, v8, v27, v28
    v_max3_f32 v8, v8, v29, v30
    v_max3_f32 v8, v8, v31, v32
    v_max3_f32 v8, v8, v33, v34
    v_max3_f32 v8, v8, v35, v36
    v_max3_f32 v8, v8, v37, v38
    v_max_f32 v8, v8, v39
    v_mov_b32 v9, v8
    s_nop 1
    v_permlane32_swap_b32 v8, v9
    v_max_f32 v8, v8, v9
    v_mov_b32 v9, v8
    s_nop 1
    v_permlane16_swap_b32 v8, v9
    v_max_f32 v8, v8, v9
    v_pk_add_f32 v[24:25], v[24:25], v[8:9] op_sel_hi:[1,0] neg_lo:[0,1] neg_hi:[0,1]
    v_pk_add_f32 v[26:27], v[26:27], v[8:9] op_sel_hi:[1,0] neg_lo:[0,1] neg_hi:[0,1]
    v_pk_add_f32 v[28:29], v[28:29], v[8:9] op_sel_hi:[1,0] neg_lo:[0,1] neg_hi:[0,1]
    v_pk_add_f32 v[30:31], v[30:31], v[8:9] op_sel_hi:[1,0] neg_lo:[0,1] neg_hi:[0,1]
    v_pk_add_f32 v[32:33], v[32:33], v[8:9] op_sel_hi:[1,0] neg_lo:[0,1] neg_hi:[0,1]
    v_pk_add_f32 v[34:35], v[34:35], v[8:9] op_sel_hi:[1,0] neg_lo:[0,1] neg_hi:[0,1]
    v_pk_add_f32 v[36:37], v[36:37], v[8:9] op_sel_hi:[1,0] neg_lo:[0,1] neg_hi:[0,1]
    v_pk_add_f32 v[38:39], v[38:39], v[8:9] op_sel_hi:[1,0] neg_lo:[0,1] neg_hi:[0,1]
    v_exp_f32 v24, v24
    v_exp_f32 v25, v25
    v_exp_f32 v26, v26
    v_exp_f32 v27, v27
    v_exp_f32 v28, v28
    v_exp_f32 v29, v29
    v_exp_f32 v30, v30
    v_exp_f32 v31, v31
    v_exp_f32 v32, v32
    v_exp_f32 v33, v33
    v_exp_f32 v34, v34
    v_exp_f32 v35, v35
    v_exp_f32 v36, v36
    v_exp_f32 v37, v37
    v_exp_f32 v38, v38
    v_exp_f32 v39, v39
    v_cvt_pk_bf16_f32 v12, v24, v25
    v_cvt_pk_bf16_f32 v13, v26, v27
    v_cvt_pk_bf16_f32 v14, v28, v29
    v_cvt_pk_bf16_f32 v15, v30, v31
    v_cvt_pk_bf16_f32 v16, v32, v33
    v_cvt_pk_bf16_f32 v17, v34, v35
    v_cvt_pk_bf16_f32 v18, v36, v37
    v_cvt_pk_bf16_f32 v19, v38, v39
    v_pk_add_f32 v[24:25], v[24:25], v[32:33]
    v_pk_add_f32 v[26:27], v[26:27], v[34:35]
    v_pk_add_f32 v[28:29], v[28:29], v[36:37]
    v_pk_add_f32 v[30:31], v[30:31], v[38:39]
    v_pk_add_f32 v[24:25], v[24:25], v[28:29]
    v_pk_add_f32 v[26:27], v[26:27], v[30:31]
    v_pk_add_f32 v[24:25], v[24:25], v[26:27]
    v_add_f32 v9, v24, v25
    v_and_b32 v60, 15, v0
    v_lshlrev_b32 v61, 10, v60
    v_lshrrev_b32 v60, 4, v0
    v_lshl_add_u32 v60, v60, 4, v61
    v_mov_b32 v10, v9
    s_nop 1
    v_permlane32_swap_b32 v9, v10
    v_add_f32 v9, v9, v10
    v_mov_b32 v10, v9
    s_nop 1
    v_permlane16_swap_b32 v9, v10
    v_add_f32 v9, v9, v10
    v_mov_b32 v10, v8
    v_mov_b32 v11, v9
    s_waitcnt lgkmcnt(6)
    v_mfma_f32_16x16x32_bf16 v[24:27], v[40:43], v[12:15], 0
    ds_read_b64_tr_b16 v[40:41], v57 offset:0
    ds_read_b64_tr_b16 v[42:43], v57 offset:4096
    s_waitcnt lgkmcnt(6)
    v_mfma_f32_16x16x32_bf16 v[24:27], v[44:47], v[16:19], v[24:27]
    ds_read_b64_tr_b16 v[44:45], v57 offset:32768
    ds_read_b64_tr_b16 v[46:47], v57 offset:36864
    s_waitcnt lgkmcnt(6)
    v_mfma_f32_16x16x32_bf16 v[28:31], v[48:51], v[12:15], 0
    ds_read_b64_tr_b16 v[48:49], v57 offset:8
    ds_read_b64_tr_b16 v[50:51], v57 offset:4104
    s_waitcnt lgkmcnt(6)
    v_mfma_f32_16x16x32_bf16 v[28:31], v[52:55], v[16:19], v[28:31]
    ds_read_b64_tr_b16 v[52:53], v57 offset:32776
    ds_read_b64_tr_b16 v[54:55], v57 offset:36872
    v_cvt_pk_bf16_f32 v32, v24, v25
    v_cvt_pk_bf16_f32 v33, v26, v27
    s_nop 3
    v_cvt_pk_bf16_f32 v34, v28, v29
    v_cvt_pk_bf16_f32 v35, v30, v31
    buffer_store_dwordx4 v[32:35], v60, s[4:7], s82 offen offset:0 sc1
    s_waitcnt lgkmcnt(6)
    v_mfma_f32_16x16x32_bf16 v[24:27], v[40:43], v[12:15], 0
    ds_read_b64_tr_b16 v[40:41], v58 offset:0
    ds_read_b64_tr_b16 v[42:43], v58 offset:4096
    s_waitcnt lgkmcnt(6)
    v_mfma_f32_16x16x32_bf16 v[24:27], v[44:47], v[16:19], v[24:27]
    ds_read_b64_tr_b16 v[44:45], v58 offset:32768
    ds_read_b64_tr_b16 v[46:47], v58 offset:36864
    s_waitcnt lgkmcnt(6)
    v_mfma_f32_16x16x32_bf16 v[28:31], v[48:51], v[12:15], 0
    ds_read_b64_tr_b16 v[48:49], v58 offset:8
    ds_read_b64_tr_b16 v[50:51], v58 offset:4104
    s_waitcnt lgkmcnt(6)
    v_mfma_f32_16x16x32_bf16 v[28:31], v[52:55], v[16:19], v[28:31]
    ds_read_b64_tr_b16 v[52:53], v58 offset:32776
    ds_read_b64_tr_b16 v[54:55], v58 offset:36872
    v_cvt_pk_bf16_f32 v36, v24, v25
    v_cvt_pk_bf16_f32 v37, v26, v27
    s_nop 3
    v_cvt_pk_bf16_f32 v38, v28, v29
    v_cvt_pk_bf16_f32 v39, v30, v31
    buffer_store_dwordx4 v[36:39], v60, s[4:7], s82 offen offset:64 sc1
    s_waitcnt lgkmcnt(6)
    v_mfma_f32_16x16x32_bf16 v[24:27], v[40:43], v[12:15], 0
    ds_read_b64_tr_b16 v[40:41], v59 offset:0
    ds_read_b64_tr_b16 v[42:43], v59 offset:4096
    s_waitcnt lgkmcnt(6)
    v_mfma_f32_16x16x32_bf16 v[24:27], v[44:47], v[16:19], v[24:27]
    ds_read_b64_tr_b16 v[44:45], v59 offset:32768
    ds_read_b64_tr_b16 v[46:47], v59 offset:36864
    s_waitcnt lgkmcnt(6)
    v_mfma_f32_16x16x32_bf16 v[28:31], v[48:51], v[12:15], 0
    ds_read_b64_tr_b16 v[48:49], v59 offset:8
    ds_read_b64_tr_b16 v[50:51], v59 offset:4104
    s_waitcnt lgkmcnt(6)
    v_mfma_f32_16x16x32_bf16 v[28:31], v[52:55], v[16:19], v[28:31]
    ds_read_b64_tr_b16 v[52:53], v59 offset:32776
    ds_read_b64_tr_b16 v[54:55], v59 offset:36872
    v_cvt_pk_bf16_f32 v32, v24, v25
    v_cvt_pk_bf16_f32 v33, v26, v27
    s_nop 3
    v_cvt_pk_bf16_f32 v34, v28, v29
    v_cvt_pk_bf16_f32 v35, v30, v31
    buffer_store_dwordx4 v[32:35], v60, s[4:7], s82 offen offset:128 sc1
    s_waitcnt lgkmcnt(6)
    v_mfma_f32_16x16x32_bf16 v[24:27], v[40:43], v[12:15], 0
    s_waitcnt lgkmcnt(4)
    v_mfma_f32_16x16x32_bf16 v[24:27], v[44:47], v[16:19], v[24:27]
    s_waitcnt lgkmcnt(2)
    v_mfma_f32_16x16x32_bf16 v[28:31], v[48:51], v[12:15], 0
    s_waitcnt lgkmcnt(0)
    v_mfma_f32_16x16x32_bf16 v[28:31], v[52:55], v[16:19], v[28:31]
    s_nop 3
    v_cvt_pk_bf16_f32 v36, v24, v25
    v_cvt_pk_bf16_f32 v37, v26, v27
    s_nop 1
    v_cvt_pk_bf16_f32 v38, v28, v29
    v_cvt_pk_bf16_f32 v39, v30, v31
    buffer_store_dwordx4 v[36:39], v60, s[4:7], s82 offen offset:192 sc1
    s_mov_b64 exec, 0xffff
    buffer_store_dwordx2 v[10:11], v61, s[4:7], s83 offen sc1
    s_mov_b64 exec, -1
    s_cmp_eq_u32 s74, 0
    s_cbranch_scc1 L_nit0_23
    v_mov_b32 v12, -1
    v_mov_b32 v13, -1
    v_mov_b32 v14, -1
    v_mov_b32 v15, -1
    s_lshl_b32 s79, s71, 2
    s_add_u32 s79, s79, s68
    s_mul_i32 s79, s79, 5632
    s_add_u32 s79, s79, 4849664
    buffer_store_dwordx4 v[12:15], v1, s[4:7], s79 offen offset:0 sc1
    buffer_store_dwordx4 v[12:15], v1, s[4:7], s79 offen offset:1024 sc1
    buffer_store_dwordx4 v[12:15], v1, s[4:7], s79 offen offset:2048 sc1
    buffer_store_dwordx4 v[12:15], v1, s[4:7], s79 offen offset:3072 sc1
    s_add_u32 s79, s79, 4096
    buffer_store_dwordx4 v[12:15], v1, s[4:7], s79 offen offset:0 sc1
    s_mov_b32 exec_lo, -1
    s_mov_b32 exec_hi, 0
    buffer_store_dwordx4 v[12:15], v1, s[4:7], s79 offen offset:1024 sc1
    s_mov_b64 exec, -1
L_nit0_23:
    s_cmp_ge_u32 s70, 5
    s_cbranch_scc1 L_ns5_24
    s_cmp_eq_u32 s74, 0
    s_cbranch_scc1 L_nit0_25
    s_mov_b32 s8, s50
    s_mov_b32 s9, s51
    s_mov_b32 s10, 5242880
    s_mov_b32 s11, 0x20000
    s_mul_i32 s79, s69, 163840
    s_mul_i32 s99, s68, 40960
    s_add_u32 s79, s79, s99
    s_mul_i32 s99, s70, 256
    s_add_u32 s79, s79, s99
    v_lshrrev_b32 v62, 4, v0
    s_mov_b32 s99, 1280
    v_mul_lo_u32 v62, v62, s99
    v_and_b32 v63, 0xf0, v1
    v_add_u32 v62, v62, v63
    s_add_u32 s78, s79, 0
    buffer_load_dwordx4 a[224:227], v62, s[8:11], s78 offen nt
    s_add_u32 s78, s79, 5120
    buffer_load_dwordx4 a[228:231], v62, s[8:11], s78 offen nt
    s_add_u32 s78, s79, 10240
    buffer_load_dwordx4 a[232:235], v62, s[8:11], s78 offen nt
    s_add_u32 s78, s79, 15360
    buffer_load_dwordx4 a[236:239], v62, s[8:11], s78 offen nt
    s_add_u32 s78, s79, 20480
    buffer_load_dwordx4 a[240:243], v62, s[8:11], s78 offen nt
    s_add_u32 s78, s79, 25600
    buffer_load_dwordx4 a[244:247], v62, s[8:11], s78 offen nt
    s_add_u32 s78, s79, 30720
    buffer_load_dwordx4 a[248:251], v62, s[8:11], s78 offen nt
    s_add_u32 s78, s79, 35840
    buffer_load_dwordx4 a[252:255], v62, s[8:11], s78 offen nt
    s_branch L_byit_26
L_nit0_25:
    s_mov_b32 s8, s50
    s_mov_b32 s9, s51
    s_mov_b32 s10, 5242880
    s_mov_b32 s11, 0x20000
    s_mul_i32 s79, s69, 163840
    s_mul_i32 s99, s68, 40960
    s_add_u32 s79, s79, s99
    s_mul_i32 s99, s70, 256
    s_add_u32 s79, s79, s99
    v_lshrrev_b32 v62, 4, v0
    s_mov_b32 s99, 1280
    v_mul_lo_u32 v62, v62, s99
    v_and_b32 v63, 0xf0, v1
    v_add_u32 v62, v62, v63
    s_add_u32 m0, s20, 0
    s_add_u32 s78, s79, 0
    buffer_load_dwordx4 v62, s[8:11], s78 offen nt lds
    s_add_u32 m0, s20, 1024
    s_add_u32 s78, s79, 5120
    buffer_load_dwordx4 v62, s[8:11], s78 offen nt lds
    s_add_u32 m0, s20, 2048
    s_add_u32 s78, s79, 10240
    buffer_load_dwordx4 v62, s[8:11], s78 offen nt lds
    s_add_u32 m0, s20, 3072
    s_add_u32 s78, s79, 15360
    buffer_load_dwordx4 v62, s[8:11], s78 offen nt lds
    s_add_u32 m0, s20, 4096
    s_add_u32 s78, s79, 20480
    buffer_load_dwordx4 v62, s[8:11], s78 offen nt lds
    s_add_u32 m0, s20, 5120
    s_add_u32 s78, s79, 25600
    buffer_load_dwordx4 v62, s[8:11], s78 offen nt lds
    s_add_u32 m0, s20, 6144
    s_add_u32 s78, s79, 30720
    buffer_load_dwordx4 v62, s[8:11], s78 offen nt lds
    s_add_u32 m0, s20, 7168
    s_add_u32 s78, s79, 35840
    buffer_load_dwordx4 v62, s[8:11], s78 offen nt lds
L_byit_26:
L_ns5_24:
    s_barrier
    s_lshr_b32 s96, s69, 4
    s_lshl_b32 s96, s96, 2
    s_lshr_b32 s97, s70, 1
    s_add_u32 s96, s96, s97
    s_lshl_b32 s96, s96, 4
    s_and_b32 s97, s69, 15
    s_add_u32 s96, s96, s97
    s_lshl_b32 s96, s96, 10
    s_add_u32 s81, s77, 393216
    s_add_u32 s81, s81, s96
    s_lshr_b32 s79, s69, 4
    s_lshl_b32 s79, s79, 7
    s_lshl_b32 s96, s68, 5
    s_add_u32 s79, s79, s96
    s_lshl_b32 s79, s79, 14
    s_and_b32 s96, s69, 15
    s_lshl_b32 s96, s96, 10
    s_add_u32 s79, s79, s96
    s_lshl_b32 s96, s70, 7
    s_add_u32 s79, s79, s96
    s_add_u32 s79, s79, 655360
    s_add_u32 s82, s79, s77
    s_add_u32 s83, s82, 131072
    s_add_u32 s84, s82, 262144
    s_add_u32 s85, s82, 393216
    s_add_u32 s86, s77, 524288
    s_mul_i32 s99, s71, 512
    s_add_u32 s86, s86, s99
    v_lshlrev_b32 v12, 3, v0
    v_lshrrev_b32 v32, 3, v0
    v_lshlrev_b32 v33, 2, v32
    v_lshlrev_b32 v32, 14, v32
    v_and_b32 v34, 7, v0
    v_lshl_add_u32 v32, v34, 4, v32
    s_and_b32 s96, s68, 1
    s_lshl_b32 s96, s96, 7
    v_add_u32 v33, s96, v33
    v_add_u32 v44, 0, v33
    v_add_u32 v45, 32, v33
    v_add_u32 v46, 64, v33
    v_add_u32 v47, 96, v33
    v_mov_b32 v52, v2
    v_mov_b32 v53, v3
    v_mov_b32 v54, v4
    v_mov_b32 v55, v5
    v_mov_b32_dpp v52, v2 row_shr:8 row_mask:0xf bank_mask:0xc
    v_mov_b32_dpp v53, v3 row_shr:8 row_mask:0xf bank_mask:0xc
    v_mov_b32_dpp v54, v4 row_shr:8 row_mask:0xf bank_mask:0xc
    v_mov_b32_dpp v55, v5 row_shr:8 row_mask:0xf bank_mask:0xc
    v_and_b32 v56, 3, v0
    v_lshrrev_b32 v57, 4, v0
    v_lshl_add_u32 v56, v56, 2, v57
    s_lshl_b32 s96, s68, 4
    v_add_u32 v56, s96, v56
    v_lshlrev_b32 v56, 2, v56
    v_add_u32 v56, 151552, v56
    v_add_u32 v57, s22, v1
    v_add_u32 v58, 147456, v1
    s_cmp_ge_u32 s70, 5
    s_cbranch_scc1 L_ns5_27
    s_waitcnt vmcnt(8)
    s_branch L_ack3_28
L_ns5_27:
    s_waitcnt vmcnt(0)
L_ack3_28:
    buffer_load_dwordx2 v[8:9], v12, s[4:7], s81 offen sc1
    buffer_load_dwordx2 v[10:11], v12, s[4:7], s81 offen offset:512 sc1
    buffer_load_dwordx4 v[16:19], v32, s[4:7], s82 offen sc1
    buffer_load_dwordx4 v[20:23], v32, s[4:7], s83 offen sc1
    buffer_load_dwordx4 v[24:27], v32, s[4:7], s84 offen sc1
    buffer_load_dwordx4 v[28:31], v32, s[4:7], s85 offen sc1
    s_cmp_eq_u32 s74, 0
    s_cbranch_scc1 L_nit0_32
    s_add_u32 s78, s76, 8192
    s_and_b32 s78, s78, 0xffff
    s_add_u32 s78, s78, s24
    buffer_load_dwordx4 v[104:107], v1, s[12:15], s78 offen offset:2048 nt
    buffer_load_dwordx4 v[108:111], v1, s[12:15], s78 offen offset:3072 nt
    s_add_u32 s78, s76, 12288
    s_and_b32 s78, s78, 0xffff
    s_add_u32 s78, s78, s24
    buffer_load_dwordx4 v[112:115], v1, s[12:15], s78 offen offset:0 nt
    buffer_load_dwordx4 v[116:119], v1, s[12:15], s78 offen offset:1024 nt
    buffer_load_dwordx4 v[120:123], v1, s[12:15], s78 offen offset:2048 nt
    buffer_load_dwordx4 v[124:127], v1, s[12:15], s78 offen offset:3072 nt
    s_add_u32 s78, s76, 16384
    s_and_b32 s78, s78, 0xffff
    s_add_u32 s78, s78, s24
    buffer_load_dwordx4 v[128:131], v1, s[12:15], s78 offen offset:0 nt
    buffer_load_dwordx4 v[132:135], v1, s[12:15], s78 offen offset:1024 nt
    buffer_load_dwordx4 v[136:139], v1, s[12:15], s78 offen offset:2048 nt
    buffer_load_dwordx4 v[140:143], v1, s[12:15], s78 offen offset:3072 nt
    s_add_u32 s78, s76, 20480
    s_and_b32 s78, s78, 0xffff
    s_add_u32 s78, s78, s24
    buffer_load_dwordx4 v[144:147], v1, s[12:15], s78 offen offset:0 nt
    buffer_load_dwordx4 v[148:151], v1, s[12:15], s78 offen offset:1024 nt
    buffer_load_dwordx4 v[152:155], v1, s[12:15], s78 offen offset:2048 nt
    buffer_load_dwordx4 v[156:159], v1, s[12:15], s78 offen offset:3072 nt
    s_add_u32 s78, s76, 24576
    s_and_b32 s78, s78, 0xffff
    s_add_u32 s78, s78, s24
    buffer_load_dwordx4 v[160:163], v1, s[12:15], s78 offen offset:0 nt
    buffer_load_dwordx4 v[164:167], v1, s[12:15], s78 offen offset:1024 nt
    buffer_load_dwordx4 v[168:171], v1, s[12:15], s78 offen offset:2048 nt
    buffer_load_dwordx4 v[172:175], v1, s[12:15], s78 offen offset:3072 nt
    s_add_u32 s78, s76, 28672
    s_and_b32 s78, s78, 0xffff
    s_add_u32 s78, s78, s24
    buffer_load_dwordx4 v[176:179], v1, s[12:15], s78 offen offset:0 nt
    buffer_load_dwordx4 v[180:183], v1, s[12:15], s78 offen offset:1024 nt
    buffer_load_dwordx4 v[184:187], v1, s[12:15], s78 offen offset:2048 nt
    buffer_load_dwordx4 v[188:191], v1, s[12:15], s78 offen offset:3072 nt
    s_add_u32 s78, s76, 32768
    s_and_b32 s78, s78, 0xffff
    s_add_u32 s78, s78, s24
    buffer_load_dwordx4 v[192:195], v1, s[12:15], s78 offen offset:0 nt
    buffer_load_dwordx4 v[196:199], v1, s[12:15], s78 offen offset:1024 nt
    s_waitcnt vmcnt(24)
    s_branch L_chk_30_b
L_nit0_32:
    s_branch L_chk_30
L_retry_29:
    s_sub_u32 s75, s75, 1
    s_cbranch_scc0 L_retry_29_go
    s_mov_b32 s75, 0
    s_branch L_done_31
L_retry_29_go:
    buffer_load_dwordx2 v[8:9], v12, s[4:7], s81 offen sc1
    buffer_load_dwordx2 v[10:11], v12, s[4:7], s81 offen offset:512 sc1
    buffer_load_dwordx4 v[16:19], v32, s[4:7], s82 offen sc1
    buffer_load_dwordx4 v[20:23], v32, s[4:7], s83 offen sc1
    buffer_load_dwordx4 v[24:27], v32, s[4:7], s84 offen sc1
    buffer_load_dwordx4 v[28:31], v32, s[4:7], s85 offen sc1
L_chk_30:
    s_waitcnt vmcnt(0)
L_chk_30_b:
    v_max3_u32 v59, v8, v9, v10
    v_max3_u32 v59, v59, v11, v16
    v_max3_u32 v59, v59, v17, v18
    v_max3_u32 v59, v59, v19, v20
    v_max3_u32 v59, v59, v21, v22
    v_max3_u32 v59, v59, v23, v24
    v_max3_u32 v59, v59, v25, v26
    v_max3_u32 v59, v59, v27, v28
    v_max3_u32 v59, v59, v29, v30
    v_max_u32 v59, v59, v31
    v_cmp_eq_u32 vcc, -1, v59
    s_nop 3
    s_cbranch_vccnz L_retry_29
L_done_31:
    v_max_f32 v12, v8, v10
    s_nop 1
    v_max_f32_dpp v12, v12, v12 row_ror:8 row_mask:0xf bank_mask:0xf
    s_nop 1
    v_max_f32_dpp v12, v12, v12 row_ror:4 row_mask:0xf bank_mask:0xf
    s_nop 1
    v_max_f32_dpp v12, v12, v12 row_ror:2 row_mask:0xf bank_mask:0xf
    s_nop 1
    v_max_f32_dpp v12, v12, v12 row_ror:1 row_mask:0xf bank_mask:0xf
    v_mov_b32 v13, v12
    s_nop 1
    v_permlane32_swap_b32 v12, v13
    v_max_f32 v12, v12, v13
    v_mov_b32 v13, v12
    s_nop 1
    v_permlane16_swap_b32 v12, v13
    v_max_f32 v12, v12, v13
    v_sub_f32 v8, v8, v12
    v_sub_f32 v10, v10, v12
    v_exp_f32 v8, v8
    v_exp_f32 v10, v10
    s_cmp_ge_u32 s68, 2
    s_cselect_b64 vcc, -1, 0
    v_mul_f32 v9, v8, v9
    v_fma_f32 v9, v10, v11, v9
    v_cndmask_b32 v8, v8, v10, vcc
    v_cvt_pk_bf16_f32 v8, v8, v8
    ds_bpermute_b32 v48, v44, v8
    ds_bpermute_b32 v49, v45, v8
    ds_bpermute_b32 v50, v46, v8
    ds_bpermute_b32 v51, v47, v8
    v_add_f32_dpp v9, v9, v9 row_ror:8 row_mask:0xf bank_mask:0xf
    s_nop 1
    v_add_f32_dpp v9, v9, v9 row_ror:4 row_mask:0xf bank_mask:0xf
    s_nop 1
    v_add_f32_dpp v9, v9, v9 row_ror:2 row_mask:0xf bank_mask:0xf
    s_nop 1
    v_add_f32_dpp v9, v9, v9 row_ror:1 row_mask:0xf bank_mask:0xf
    v_mov_b32 v13, v9
    s_nop 1
    v_permlane32_swap_b32 v9, v13
    v_add_f32 v9, v9, v13
    v_mov_b32 v13, v9
    s_nop 1
    v_permlane16_swap_b32 v9, v13
    v_add_f32 v9, v9, v13
    v_rcp_f32 v9, v9
    s_waitcnt lgkmcnt(3)
    v_and_b32 v32, v48, v52
    v_and_b32 v33, v48, v53
    v_and_b32 v34, v48, v54
    v_and_b32 v35, v48, v55
    s_waitcnt lgkmcnt(2)
    v_and_b32 v36, v49, v52
    v_and_b32 v37, v49, v53
    v_and_b32 v38, v49, v54
    v_and_b32 v39, v49, v55
    v_mfma_f32_16x16x32_bf16 v[40:43], v[16:19], v[32:35], 0
    s_waitcnt lgkmcnt(1)
    v_and_b32 v32, v50, v52
    v_and_b32 v33, v50, v53
    v_and_b32 v34, v50, v54
    v_and_b32 v35, v50, v55
    v_mfma_f32_16x16x32_bf16 v[40:43], v[20:23], v[36:39], v[40:43]
    s_waitcnt lgkmcnt(0)
    v_and_b32 v36, v51, v52
    v_and_b32 v37, v51, v53
    v_and_b32 v38, v51, v54
    v_and_b32 v39, v51, v55
    v_mfma_f32_16x16x32_bf16 v[40:43], v[24:27], v[32:35], v[40:43]
    s_nop 0
    v_mfma_f32_16x16x32_bf16 v[40:43], v[28:31], v[36:39], v[40:43]
    s_nop 7
    ds_write_b32 v7, v40 offset:4096
    ds_write_b32 v7, v41 offset:4128
    ds_write_b32 v7, v42 offset:4160
    ds_write_b32 v7, v43 offset:4192
    ds_read_b128 v[16:19], v57 offset:0
    ds_read_b128 v[20:23], v57 offset:1024
    ds_read_b128 v[24:27], v57 offset:2048
    ds_read_b128 v[28:31], v57 offset:3072
    s_waitcnt lgkmcnt(4)
    s_barrier
    ds_read_b32 v44, v56 offset:0
    ds_read_b32 v45, v56 offset:768
    ds_read_b32 v46, v56 offset:1024
    ds_read_b32 v47, v56 offset:1792
    ds_read_b32 v48, v56 offset:2048
    ds_read_b32 v49, v56 offset:2816
    ds_read_b32 v50, v56 offset:3072
    ds_read_b32 v51, v56 offset:3840
    s_waitcnt lgkmcnt(0)
    v_pk_add_f32 v[44:45], v[44:45], v[48:49]
    v_pk_add_f32 v[46:47], v[46:47], v[50:51]
    v_pk_add_f32 v[44:45], v[44:45], v[46:47]
    v_add_f32 v44, v44, v45
    v_mul_f32 v44, v44, v9
    v_cvt_pk_bf16_f32 v44, v44, v44
    s_nop 1
    v_and_b32_dpp v32, v44, v2 row_newbcast:0 row_mask:0xf bank_mask:0xf
    v_and_b32_dpp v33, v44, v3 row_newbcast:0 row_mask:0xf bank_mask:0xf
    v_and_b32_dpp v34, v44, v4 row_newbcast:0 row_mask:0xf bank_mask:0xf
    v_and_b32_dpp v35, v44, v5 row_newbcast:0 row_mask:0xf bank_mask:0xf
    v_and_b32_dpp v36, v44, v2 row_newbcast:1 row_mask:0xf bank_mask:0xf
    v_and_b32_dpp v37, v44, v3 row_newbcast:1 row_mask:0xf bank_mask:0xf
    v_and_b32_dpp v38, v44, v4 row_newbcast:1 row_mask:0xf bank_mask:0xf
    v_and_b32_dpp v39, v44, v5 row_newbcast:1 row_mask:0xf bank_mask:0xf
    v_mfma_f32_16x16x32_bf16 v[40:43], v[16:19], v[32:35], 0
    v_and_b32_dpp v32, v44, v2 row_newbcast:2 row_mask:0xf bank_mask:0xf
    v_and_b32_dpp v33, v44, v3 row_newbcast:2 row_mask:0xf bank_mask:0xf
    v_and_b32_dpp v34, v44, v4 row_newbcast:2 row_mask:0xf bank_mask:0xf
    v_and_b32_dpp v35, v44, v5 row_newbcast:2 row_mask:0xf bank_mask:0xf
    v_mfma_f32_16x16x32_bf16 v[40:43], v[20:23], v[36:39], v[40:43]
    v_and_b32_dpp v36, v44, v2 row_newbcast:3 row_mask:0xf bank_mask:0xf
    v_and_b32_dpp v37, v44, v3 row_newbcast:3 row_mask:0xf bank_mask:0xf
    v_and_b32_dpp v38, v44, v4 row_newbcast:3 row_mask:0xf bank_mask:0xf
    v_and_b32_dpp v39, v44, v5 row_newbcast:3 row_mask:0xf bank_mask:0xf
    v_mfma_f32_16x16x32_bf16 v[40:43], v[24:27], v[32:35], v[40:43]
    s_nop 0
    v_mfma_f32_16x16x32_bf16 v[40:43], v[28:31], v[36:39], v[40:43]
    s_nop 7
    ds_write_b32 v7, v40 offset:0
    ds_write_b32 v7, v41 offset:32
    ds_write_b32 v7, v42 offset:64
    ds_write_b32 v7, v43 offset:96
    s_waitcnt lgkmcnt(0)
    s_barrier
    s_cmp_lg_u32 s68, 0
    s_cbranch_scc1 L_nw0_33
    ds_read_b128 v[8:11], v58 offset:0
    ds_read_b128 v[12:15], v58 offset:1024
    ds_read_b128 v[16:19], v58 offset:2048
    ds_read_b128 v[20:23], v58 offset:3072
    s_waitcnt lgkmcnt(2)
    v_pk_add_f32 v[8:9], v[8:9], v[12:13]
    v_pk_add_f32 v[10:11], v[10:11], v[14:15]
    s_waitcnt lgkmcnt(0)
    v_pk_add_f32 v[16:17], v[16:17], v[20:21]
    v_pk_add_f32 v[18:19], v[18:19], v[22:23]
    v_pk_add_f32 v[8:9], v[8:9], v[16:17]
    v_pk_add_f32 v[10:11], v[10:11], v[18:19]
    s_mov_b32 exec_lo, -1
    s_mov_b32 exec_hi, 0
    s_cmp_eq_u32 s34, 0
    s_cbranch_scc1 L_gst_34
    buffer_store_dwordx4 v[8:11], v1, s[4:7], s86 offen
    s_nop 0
    s_branch L_gste_35
L_gst_34:
    buffer_store_dwordx4 v[8:11], v1, s[4:7], s86 offen sc1
L_gste_35:
    s_mov_b64 exec, -1
L_nw0_33:
    s_cmp_ge_u32 s70, 5
    s_cbranch_scc1 L_ns5_36
    s_add_u32 s81, s77, 524288
    s_mul_i32 s99, s69, 4096
    s_add_u32 s81, s81, s99
    s_add_u32 s83, s77, 294912
    s_mul_i32 s99, s69, 1280
    s_add_u32 s83, s83, s99
    s_mul_i32 s99, s70, 256
    s_add_u32 s83, s83, s99
    s_add_u32 s84, s77, 339968
    s_mul_i32 s99, s69, 128
    s_add_u32 s84, s84, s99
    v_and_b32 v26, 7, v0
    v_lshlrev_b32 v27, 2, v26
    v_lshlrev_b32 v26, 3, v26
    v_lshrrev_b32 v60, 4, v0
    v_add_u32 v60, v60, v27
    s_lshl_b32 s96, s68, 5
    v_add_u32 v60, s96, v60
    v_lshlrev_b32 v60, 1, v60
    v_add_u32 v60, 155648, v60
    v_lshlrev_b32 v61, 3, v0
    v_add_u32 v62, 155648, v61
    v_add_u32 v63, 147456, v1
    s_cmp_eq_u32 s74, 0
    s_cbranch_scc1 L_nit0_37
    s_waitcnt vmcnt(9)
    s_branch L_gackk_38
L_nit0_37:
    s_cmp_eq_u32 s34, 0
    s_cbranch_scc1 L_gack_39
    s_waitcnt vmcnt(1)
    s_branch L_gack2_40
L_gack_39:
    s_waitcnt vmcnt(0)
L_gack2_40:
L_gackk_38:
    s_cmp_eq_u32 s68, 0
    s_cbranch_scc1 L_w0poll_42
    s_cmp_eq_u32 s74, 0
    s_cbranch_scc1 L_nit0_43
    v_accvgpr_read_b32 v28, a224
    v_accvgpr_read_b32 v29, a225
    v_accvgpr_read_b32 v30, a226
    v_accvgpr_read_b32 v31, a227
    v_accvgpr_read_b32 v32, a228
    v_accvgpr_read_b32 v33, a229
    v_accvgpr_read_b32 v34, a230
    v_accvgpr_read_b32 v35, a231
    v_accvgpr_read_b32 v36, a232
    v_accvgpr_read_b32 v37, a233
    v_accvgpr_read_b32 v38, a234
    v_accvgpr_read_b32 v39, a235
    v_accvgpr_read_b32 v40, a236
    v_accvgpr_read_b32 v41, a237
    v_accvgpr_read_b32 v42, a238
    v_accvgpr_read_b32 v43, a239
    v_accvgpr_read_b32 v44, a240
    v_accvgpr_read_b32 v45, a241
    v_accvgpr_read_b32 v46, a242
    v_accvgpr_read_b32 v47, a243
    v_accvgpr_read_b32 v48, a244
    v_accvgpr_read_b32 v49, a245
    v_accvgpr_read_b32 v50, a246
    v_accvgpr_read_b32 v51, a247
    v_accvgpr_read_b32 v52, a248
    v_accvgpr_read_b32 v53, a249
    v_accvgpr_read_b32 v54, a250
    v_accvgpr_read_b32 v55, a251
    v_accvgpr_read_b32 v56, a252
    v_accvgpr_read_b32 v57, a253
    v_accvgpr_read_b32 v58, a254
    v_accvgpr_read_b32 v59, a255
    s_nop 0
    s_branch L_byit_44
L_nit0_43:
    v_add_u32 v27, s20, v1
    ds_read_b128 v[28:31], v27 offset:0
    ds_read_b128 v[32:35], v27 offset:1024
    ds_read_b128 v[36:39], v27 offset:2048
    ds_read_b128 v[40:43], v27 offset:3072
    ds_read_b128 v[44:47], v27 offset:4096
    ds_read_b128 v[48:51], v27 offset:5120
    ds_read_b128 v[52:55], v27 offset:6144
    ds_read_b128 v[56:59], v27 offset:7168
L_byit_44:
    s_cmp_eq_u32 s74, 0
    s_cbranch_scc1 L_nit0_45
    s_add_u32 s78, s76, 32768
    s_and_b32 s78, s78, 0xffff
    s_add_u32 s78, s78, s24
    buffer_load_dwordx4 v[200:203], v1, s[12:15], s78 offen offset:2048 nt
    buffer_load_dwordx4 v[204:207], v1, s[12:15], s78 offen offset:3072 nt
    s_add_u32 s78, s76, 36864
    s_and_b32 s78, s78, 0xffff
    s_add_u32 s78, s78, s24
    buffer_load_dwordx4 v[208:211], v1, s[12:15], s78 offen offset:0 nt
    buffer_load_dwordx4 v[212:215], v1, s[12:15], s78 offen offset:1024 nt
    buffer_load_dwordx4 v[216:219], v1, s[12:15], s78 offen offset:2048 nt
    buffer_load_dwordx4 v[220:223], v1, s[12:15], s78 offen offset:3072 nt
    s_add_u32 s78, s76, 40960
    s_and_b32 s78, s78, 0xffff
    s_add_u32 s78, s78, s24
    buffer_load_dwordx4 v[224:227], v1, s[12:15], s78 offen offset:0 nt
    buffer_load_dwordx4 v[228:231], v1, s[12:15], s78 offen offset:1024 nt
    buffer_load_dwordx4 v[232:235], v1, s[12:15], s78 offen offset:2048 nt
    buffer_load_dwordx4 v[236:239], v1, s[12:15], s78 offen offset:3072 nt
    s_add_u32 s78, s76, 45056
    s_and_b32 s78, s78, 0xffff
    s_add_u32 s78, s78, s24
    buffer_load_dwordx4 v[240:243], v1, s[12:15], s78 offen offset:0 nt
    buffer_load_dwordx4 v[244:247], v1, s[12:15], s78 offen offset:1024 nt
    buffer_load_dwordx4 v[248:251], v1, s[12:15], s78 offen offset:2048 nt
    buffer_load_dwordx4 v[252:255], v1, s[12:15], s78 offen offset:3072 nt
    s_add_u32 s78, s76, 49152
    s_and_b32 s78, s78, 0xffff
    s_add_u32 s78, s78, s24
    s_add_u32 m0, s23, 0
    s_nop 0
    buffer_load_dwordx4 v1, s[12:15], s78 offen offset:0 nt lds
    s_add_u32 m0, s23, 0
    s_nop 0
    buffer_load_dwordx4 v1, s[12:15], s78 offen offset:1024 nt lds
    s_add_u32 m0, s23, 0
    s_nop 0
    buffer_load_dwordx4 v1, s[12:15], s78 offen offset:2048 nt lds
    s_add_u32 m0, s23, 0
    s_nop 0
    buffer_load_dwordx4 v1, s[12:15], s78 offen offset:3072 nt lds
    s_add_u32 s78, s76, 53248
    s_and_b32 s78, s78, 0xffff
    s_add_u32 s78, s78, s24
    s_add_u32 m0, s23, 4096
    s_nop 0
    buffer_load_dwordx4 v1, s[12:15], s78 offen offset:0 nt lds
    s_add_u32 m0, s23, 4096
    s_nop 0
    buffer_load_dwordx4 v1, s[12:15], s78 offen offset:1024 nt lds
    s_add_u32 m0, s23, 4096
    s_nop 0
    buffer_load_dwordx4 v1, s[12:15], s78 offen offset:2048 nt lds
    s_add_u32 m0, s23, 4096
    s_nop 0
    buffer_load_dwordx4 v1, s[12:15], s78 offen offset:3072 nt lds
    s_add_u32 s78, s76, 57344
    s_and_b32 s78, s78, 0xffff
    s_add_u32 s78, s78, s24
    s_add_u32 m0, s23, 8192
    s_nop 0
    buffer_load_dwordx4 v1, s[12:15], s78 offen offset:0 nt lds
    s_add_u32 m0, s23, 8192
    s_nop 0
    buffer_load_dwordx4 v1, s[12:15], s78 offen offset:1024 nt lds
L_nit0_45:
    s_branch L_nopoll_41
L_w0poll_42:
    buffer_load_dwordx4 v[8:11], v1, s[4:7], s81 offen offset:0 sc1
    buffer_load_dwordx4 v[12:15], v1, s[4:7], s81 offen offset:1024 sc1
    buffer_load_dwordx4 v[16:19], v1, s[4:7], s81 offen offset:2048 sc1
    buffer_load_dwordx4 v[20:23], v1, s[4:7], s81 offen offset:3072 sc1
    s_cmp_eq_u32 s74, 0
    s_cbranch_scc1 L_nit0_49
    v_accvgpr_read_b32 v28, a224
    v_accvgpr_read_b32 v29, a225
    v_accvgpr_read_b32 v30, a226
    v_accvgpr_read_b32 v31, a227
    v_accvgpr_read_b32 v32, a228
    v_accvgpr_read_b32 v33, a229
    v_accvgpr_read_b32 v34, a230
    v_accvgpr_read_b32 v35, a231
    v_accvgpr_read_b32 v36, a232
    v_accvgpr_read_b32 v37, a233
    v_accvgpr_read_b32 v38, a234
    v_accvgpr_read_b32 v39, a235
    v_accvgpr_read_b32 v40, a236
    v_accvgpr_read_b32 v41, a237
    v_accvgpr_read_b32 v42, a238
    v_accvgpr_read_b32 v43, a239
    v_accvgpr_read_b32 v44, a240
    v_accvgpr_read_b32 v45, a241
    v_accvgpr_read_b32 v46, a242
    v_accvgpr_read_b32 v47, a243
    v_accvgpr_read_b32 v48, a244
    v_accvgpr_read_b32 v49, a245
    v_accvgpr_read_b32 v50, a246
    v_accvgpr_read_b32 v51, a247
    v_accvgpr_read_b32 v52, a248
    v_accvgpr_read_b32 v53, a249
    v_accvgpr_read_b32 v54, a250
    v_accvgpr_read_b32 v55, a251
    v_accvgpr_read_b32 v56, a252
    v_accvgpr_read_b32 v57, a253
    v_accvgpr_read_b32 v58, a254
    v_accvgpr_read_b32 v59, a255
    s_nop 0
    s_branch L_byit_50
L_nit0_49:
    v_add_u32 v27, s20, v1
    ds_read_b128 v[28:31], v27 offset:0
    ds_read_b128 v[32:35], v27 offset:1024
    ds_read_b128 v[36:39], v27 offset:2048
    ds_read_b128 v[40:43], v27 offset:3072
    ds_read_b128 v[44:47], v27 offset:4096
    ds_read_b128 v[48:51], v27 offset:5120
    ds_read_b128 v[52:55], v27 offset:6144
    ds_read_b128 v[56:59], v27 offset:7168
L_byit_50:
    s_cmp_eq_u32 s74, 0
    s_cbranch_scc1 L_nit0_51
    s_add_u32 s78, s76, 32768
    s_and_b32 s78, s78, 0xffff
    s_add_u32 s78, s78, s24
    buffer_load_dwordx4 v[200:203], v1, s[12:15], s78 offen offset:2048 nt
    buffer_load_dwordx4 v[204:207], v1, s[12:15], s78 offen offset:3072 nt
    s_add_u32 s78, s76, 36864
    s_and_b32 s78, s78, 0xffff
    s_add_u32 s78, s78, s24
    buffer_load_dwordx4 v[208:211], v1, s[12:15], s78 offen offset:0 nt
    buffer_load_dwordx4 v[212:215], v1, s[12:15], s78 offen offset:1024 nt
    buffer_load_dwordx4 v[216:219], v1, s[12:15], s78 offen offset:2048 nt
    buffer_load_dwordx4 v[220:223], v1, s[12:15], s78 offen offset:3072 nt
    s_add_u32 s78, s76, 40960
    s_and_b32 s78, s78, 0xffff
    s_add_u32 s78, s78, s24
    buffer_load_dwordx4 v[224:227], v1, s[12:15], s78 offen offset:0 nt
    buffer_load_dwordx4 v[228:231], v1, s[12:15], s78 offen offset:1024 nt
    buffer_load_dwordx4 v[232:235], v1, s[12:15], s78 offen offset:2048 nt
    buffer_load_dwordx4 v[236:239], v1, s[12:15], s78 offen offset:3072 nt
    s_add_u32 s78, s76, 45056
    s_and_b32 s78, s78, 0xffff
    s_add_u32 s78, s78, s24
    buffer_load_dwordx4 v[240:243], v1, s[12:15], s78 offen offset:0 nt
    buffer_load_dwordx4 v[244:247], v1, s[12:15], s78 offen offset:1024 nt
    buffer_load_dwordx4 v[248:251], v1, s[12:15], s78 offen offset:2048 nt
    buffer_load_dwordx4 v[252:255], v1, s[12:15], s78 offen offset:3072 nt
    s_add_u32 s78, s76, 49152
    s_and_b32 s78, s78, 0xffff
    s_add_u32 s78, s78, s24
    s_add_u32 m0, s23, 0
    s_nop 0
    buffer_load_dwordx4 v1, s[12:15], s78 offen offset:0 nt lds
    s_add_u32 m0, s23, 0
    s_nop 0
    buffer_load_dwordx4 v1, s[12:15], s78 offen offset:1024 nt lds
    s_add_u32 m0, s23, 0
    s_nop 0
    buffer_load_dwordx4 v1, s[12:15], s78 offen offset:2048 nt lds
    s_add_u32 m0, s23, 0
    s_nop 0
    buffer_load_dwordx4 v1, s[12:15], s78 offen offset:3072 nt lds
    s_add_u32 s78, s76, 53248
    s_and_b32 s78, s78, 0xffff
    s_add_u32 s78, s78, s24
    s_add_u32 m0, s23, 4096
    s_nop 0
    buffer_load_dwordx4 v1, s[12:15], s78 offen offset:0 nt lds
    s_add_u32 m0, s23, 4096
    s_nop 0
    buffer_load_dwordx4 v1, s[12:15], s78 offen offset:1024 nt lds
    s_add_u32 m0, s23, 4096
    s_nop 0
    buffer_load_dwordx4 v1, s[12:15], s78 offen offset:2048 nt lds
    s_add_u32 m0, s23, 4096
    s_nop 0
    buffer_load_dwordx4 v1, s[12:15], s78 offen offset:3072 nt lds
    s_add_u32 s78, s76, 57344
    s_and_b32 s78, s78, 0xffff
    s_add_u32 s78, s78, s24
    s_add_u32 m0, s23, 8192
    s_nop 0
    buffer_load_dwordx4 v1, s[12:15], s78 offen offset:0 nt lds
    s_add_u32 m0, s23, 8192
    s_nop 0
    buffer_load_dwordx4 v1, s[12:15], s78 offen offset:1024 nt lds
    s_waitcnt vmcnt(24)
    s_branch L_chk_47_b
L_nit0_51:
    s_branch L_chk_47
L_retry_46:
    s_sub_u32 s75, s75, 1
    s_cbranch_scc0 L_retry_46_go
    s_mov_b32 s75, 0
    s_branch L_done_48
L_retry_46_go:
    buffer_load_dwordx4 v[8:11], v1, s[4:7], s81 offen offset:0 sc1
    buffer_load_dwordx4 v[12:15], v1, s[4:7], s81 offen offset:1024 sc1
    buffer_load_dwordx4 v[16:19], v1, s[4:7], s81 offen offset:2048 sc1
    buffer_load_dwordx4 v[20:23], v1, s[4:7], s81 offen offset:3072 sc1
L_chk_47:
    s_waitcnt vmcnt(0)
L_chk_47_b:
    v_pk_add_f32 v[8:9], v[8:9], v[12:13]
    v_pk_add_f32 v[10:11], v[10:11], v[14:15]
    v_pk_add_f32 v[16:17], v[16:17], v[20:21]
    v_pk_add_f32 v[18:19], v[18:19], v[22:23]
    v_pk_add_f32 v[8:9], v[8:9], v[16:17]
    v_pk_add_f32 v[10:11], v[10:11], v[18:19]
    v_add_f32 v12, v8, v9
    v_add_f32 v13, v10, v11
    v_add_f32 v12, v12, v13
    v_cmp_u_f32 vcc, v12, v12
    s_nop 3
    s_cbranch_vccnz L_retry_46
L_done_48:
    v_mov_b32 v12, v8
    v_mov_b32 v13, v9
    v_mov_b32 v14, v10
    v_mov_b32 v15, v11
    v_permlane32_swap_b32 v8, v12
    v_permlane32_swap_b32 v9, v13
    v_permlane32_swap_b32 v10, v14
    v_permlane32_swap_b32 v11, v15
    v_add_f32 v8, v8, v12
    v_add_f32 v9, v9, v13
    v_add_f32 v10, v10, v14
    v_add_f32 v11, v11, v15
    v_cvt_pk_bf16_f32 v12, v8, v9
    v_cvt_pk_bf16_f32 v13, v10, v11
    ds_write_b64 v62, v[12:13]
    s_waitcnt lgkmcnt(0)
L_nopoll_41:
    s_barrier
    ds_read_u16 v8, v60
    s_waitcnt lgkmcnt(0)
    v_lshl_or_b32 v8, v8, 16, v8
    s_nop 1
    v_and_b32_dpp v12, v8, v2 row_newbcast:0 row_mask:0xf bank_mask:0xf
    v_and_b32_dpp v13, v8, v3 row_newbcast:0 row_mask:0xf bank_mask:0xf
    v_and_b32_dpp v14, v8, v4 row_newbcast:0 row_mask:0xf bank_mask:0xf
    v_and_b32_dpp v15, v8, v5 row_newbcast:0 row_mask:0xf bank_mask:0xf
    v_and_b32_dpp v16, v8, v2 row_newbcast:1 row_mask:0xf bank_mask:0xf
    v_and_b32_dpp v17, v8, v3 row_newbcast:1 row_mask:0xf bank_mask:0xf
    v_and_b32_dpp v18, v8, v4 row_newbcast:1 row_mask:0xf bank_mask:0xf
    v_and_b32_dpp v19, v8, v5 row_newbcast:1 row_mask:0xf bank_mask:0xf
    v_mfma_f32_16x16x32_bf16 v[20:23], v[28:31], v[12:15], 0
    v_and_b32_dpp v12, v8, v2 row_newbcast:2 row_mask:0xf bank_mask:0xf
    v_and_b32_dpp v13, v8, v3 row_newbcast:2 row_mask:0xf bank_mask:0xf
    v_and_b32_dpp v14, v8, v4 row_newbcast:2 row_mask:0xf bank_mask:0xf
    v_and_b32_dpp v15, v8, v5 row_newbcast:2 row_mask:0xf bank_mask:0xf
    v_mfma_f32_16x16x32_bf16 v[20:23], v[32:35], v[16:19], v[20:23]
    v_and_b32_dpp v16, v8, v2 row_newbcast:3 row_mask:0xf bank_mask:0xf
    v_and_b32_dpp v17, v8, v3 row_newbcast:3 row_mask:0xf bank_mask:0xf
    v_and_b32_dpp v18, v8, v4 row_newbcast:3 row_mask:0xf bank_mask:0xf
    v_and_b32_dpp v19, v8, v5 row_newbcast:3 row_mask:0xf bank_mask:0xf
    v_mfma_f32_16x16x32_bf16 v[20:23], v[36:39], v[12:15], v[20:23]
    v_and_b32_dpp v12, v8, v2 row_newbcast:4 row_mask:0xf bank_mask:0xf
    v_and_b32_dpp v13, v8, v3 row_newbcast:4 row_mask:0xf bank_mask:0xf
    v_and_b32_dpp v14, v8, v4 row_newbcast:4 row_mask:0xf bank_mask:0xf
    v_and_b32_dpp v15, v8, v5 row_newbcast:4 row_mask:0xf bank_mask:0xf
    v_mfma_f32_16x16x32_bf16 v[20:23], v[40:43], v[16:19], v[20:23]
    v_and_b32_dpp v16, v8, v2 row_newbcast:5 row_mask:0xf bank_mask:0xf
    v_and_b32_dpp v17, v8, v3 row_newbcast:5 row_mask:0xf bank_mask:0xf
    v_and_b32_dpp v18, v8, v4 row_newbcast:5 row_mask:0xf bank_mask:0xf
    v_and_b32_dpp v19, v8, v5 row_newbcast:5 row_mask:0xf bank_mask:0xf
    v_mfma_f32_16x16x32_bf16 v[20:23], v[44:47], v[12:15], v[20:23]
    v_and_b32_dpp v12, v8, v2 row_newbcast:6 row_mask:0xf bank_mask:0xf
    v_and_b32_dpp v13, v8, v3 row_newbcast:6 row_mask:0xf bank_mask:0xf
    v_and_b32_dpp v14, v8, v4 row_newbcast:6 row_mask:0xf bank_mask:0xf
    v_and_b32_dpp v15, v8, v5 row_newbcast:6 row_mask:0xf bank_mask:0xf
    v_mfma_f32_16x16x32_bf16 v[20:23], v[48:51], v[16:19], v[20:23]
    v_and_b32_dpp v16, v8, v2 row_newbcast:7 row_mask:0xf bank_mask:0xf
    v_and_b32_dpp v17, v8, v3 row_newbcast:7 row_mask:0xf bank_mask:0xf
    v_and_b32_dpp v18, v8, v4 row_newbcast:7 row_mask:0xf bank_mask:0xf
    v_and_b32_dpp v19, v8, v5 row_newbcast:7 row_mask:0xf bank_mask:0xf
    v_mfma_f32_16x16x32_bf16 v[20:23], v[52:55], v[12:15], v[20:23]
    s_nop 0
    v_mfma_f32_16x16x32_bf16 v[20:23], v[56:59], v[16:19], v[20:23]
    s_nop 7
    ds_write_b32 v7, v20 offset:0
    ds_write_b32 v7, v21 offset:32
    ds_write_b32 v7, v22 offset:64
    ds_write_b32 v7, v23 offset:96
    s_waitcnt lgkmcnt(0)
    s_barrier
    s_cmp_lg_u32 s68, 0
    s_cbranch_scc1 L_nw0_52
    ds_read_b128 v[8:11], v63 offset:0
    ds_read_b128 v[12:15], v63 offset:1024
    ds_read_b128 v[16:19], v63 offset:2048
    ds_read_b128 v[20:23], v63 offset:3072
    s_waitcnt lgkmcnt(2)
    v_pk_add_f32 v[8:9], v[8:9], v[12:13]
    v_pk_add_f32 v[10:11], v[10:11], v[14:15]
    s_waitcnt lgkmcnt(0)
    v_pk_add_f32 v[16:17], v[16:17], v[20:21]
    v_pk_add_f32 v[18:19], v[18:19], v[22:23]
    v_pk_add_f32 v[8:9], v[8:9], v[16:17]
    v_pk_add_f32 v[10:11], v[10:11], v[18:19]
    v_cvt_pk_bf16_f32 v8, v8, v9
    v_cvt_pk_bf16_f32 v9, v10, v11
    s_mov_b32 exec_lo, -1
    s_mov_b32 exec_hi, 0
    buffer_store_dwordx2 v[8:9], v61, s[4:7], s83 offen sc1
    s_mov_b64 exec, -1
    s_cmp_lg_u32 s70, 0
    s_cbranch_scc1 L_nohx_53
    v_mov_b32 v10, 0
    s_mov_b64 exec, 1
    buffer_store_dword v10, off, s[4:7], s84 sc1
    s_mov_b64 exec, -1
L_nohx_53:
L_nw0_52:
    s_branch L_opend_54
L_ns5_36:
    s_cmp_eq_u32 s74, 0
    s_cbranch_scc1 L_nit0_55
    s_add_u32 s78, s76, 32768
    s_and_b32 s78, s78, 0xffff
    s_add_u32 s78, s78, s24
    buffer_load_dwordx4 v[200:203], v1, s[12:15], s78 offen offset:2048 nt
    buffer_load_dwordx4 v[204:207], v1, s[12:15], s78 offen offset:3072 nt
    s_add_u32 s78, s76, 36864
    s_and_b32 s78, s78, 0xffff
    s_add_u32 s78, s78, s24
    buffer_load_dwordx4 v[208:211], v1, s[12:15], s78 offen offset:0 nt
    buffer_load_dwordx4 v[212:215], v1, s[12:15], s78 offen offset:1024 nt
    buffer_load_dwordx4 v[216:219], v1, s[12:15], s78 offen offset:2048 nt
    buffer_load_dwordx4 v[220:223], v1, s[12:15], s78 offen offset:3072 nt
    s_add_u32 s78, s76, 40960
    s_and_b32 s78, s78, 0xffff
    s_add_u32 s78, s78, s24
    buffer_load_dwordx4 v[224:227], v1, s[12:15], s78 offen offset:0 nt
    buffer_load_dwordx4 v[228:231], v1, s[12:15], s78 offen offset:1024 nt
    buffer_load_dwordx4 v[232:235], v1, s[12:15], s78 offen offset:2048 nt
    buffer_load_dwordx4 v[236:239], v1, s[12:15], s78 offen offset:3072 nt
    s_add_u32 s78, s76, 45056
    s_and_b32 s78, s78, 0xffff
    s_add_u32 s78, s78, s24
    buffer_load_dwordx4 v[240:243], v1, s[12:15], s78 offen offset:0 nt
    buffer_load_dwordx4 v[244:247], v1, s[12:15], s78 offen offset:1024 nt
    buffer_load_dwordx4 v[248:251], v1, s[12:15], s78 offen offset:2048 nt
    buffer_load_dwordx4 v[252:255], v1, s[12:15], s78 offen offset:3072 nt
    s_add_u32 s78, s76, 49152
    s_and_b32 s78, s78, 0xffff
    s_add_u32 s78, s78, s24
    s_add_u32 m0, s23, 0
    s_nop 0
    buffer_load_dwordx4 v1, s[12:15], s78 offen offset:0 nt lds
    s_add_u32 m0, s23, 0
    s_nop 0
    buffer_load_dwordx4 v1, s[12:15], s78 offen offset:1024 nt lds
    s_add_u32 m0, s23, 0
    s_nop 0
    buffer_load_dwordx4 v1, s[12:15], s78 offen offset:2048 nt lds
    s_add_u32 m0, s23, 0
    s_nop 0
    buffer_load_dwordx4 v1, s[12:15], s78 offen offset:3072 nt lds
    s_add_u32 s78, s76, 53248
    s_and_b32 s78, s78, 0xffff
    s_add_u32 s78, s78, s24
    s_add_u32 m0, s23, 4096
    s_nop 0
    buffer_load_dwordx4 v1, s[12:15], s78 offen offset:0 nt lds
    s_add_u32 m0, s23, 4096
    s_nop 0
    buffer_load_dwordx4 v1, s[12:15], s78 offen offset:1024 nt lds
    s_add_u32 m0, s23, 4096
    s_nop 0
    buffer_load_dwordx4 v1, s[12:15], s78 offen offset:2048 nt lds
    s_add_u32 m0, s23, 4096
    s_nop 0
    buffer_load_dwordx4 v1, s[12:15], s78 offen offset:3072 nt lds
    s_add_u32 s78, s76, 57344
    s_and_b32 s78, s78, 0xffff
    s_add_u32 s78, s78, s24
    s_add_u32 m0, s23, 8192
    s_nop 0
    buffer_load_dwordx4 v1, s[12:15], s78 offen offset:0 nt lds
    s_add_u32 m0, s23, 8192
    s_nop 0
    buffer_load_dwordx4 v1, s[12:15], s78 offen offset:1024 nt lds
L_nit0_55:
L_opend_54:
    s_add_u32 s81, s77, 294912
    s_mul_i32 s99, s68, 10240
    s_add_u32 s81, s81, s99
    s_mul_i32 s99, s70, 160
    s_add_u32 s81, s81, s99
    s_add_u32 s82, s81, 5120
    s_add_u32 s83, s77, 339968
    s_mul_i32 s99, s69, 128
    s_add_u32 s83, s83, s99
    v_and_b32 v8, 15, v0
    v_min_u32 v24, 9, v8
    v_lshlrev_b32 v24, 4, v24
    v_lshrrev_b32 v9, 4, v0
    v_mul_u32_u24 v25, 1280, v9
    v_add_u32 v24, v24, v25
    v_cmp_gt_u32 vcc, 5, v8
    v_mov_b32 v25, 0xffff0000
    s_nop 0
    v_cndmask_b32 v25, 0, v25, vcc
    v_lshl_add_u32 v9, v8, 2, v9
    s_mul_i32 s96, s68, 20
    v_add_u32 v9, s96, v9
    v_min_u32 v9, 127, v9
    v_lshlrev_b32 v9, 2, v9
    v_add_u32 v27, 151552, v9
    v_and_b32 v20, 0x3f803f80, v2
    v_and_b32 v21, 0x3f803f80, v3
    v_and_b32 v22, 0x3f803f80, v4
    v_and_b32 v23, 0x3f803f80, v5
    v_mov_b32 v32, 0
    v_mov_b32 v33, 0
    v_mov_b32 v34, 0
    v_mov_b32 v35, 0
    v_mov_b32_dpp v32, v2 row_shr:8 row_mask:0xf bank_mask:0xc
    v_mov_b32_dpp v33, v3 row_shr:8 row_mask:0xf bank_mask:0xc
    v_mov_b32_dpp v34, v4 row_shr:8 row_mask:0xf bank_mask:0xc
    v_mov_b32_dpp v35, v5 row_shr:8 row_mask:0xf bank_mask:0xc
    v_and_b32 v32, 0x3f803f80, v32
    v_and_b32 v33, 0x3f803f80, v33
    v_and_b32 v34, 0x3f803f80, v34
    v_and_b32 v35, 0x3f803f80, v35
    v_mov_b32 v36, v32
    v_mov_b32 v37, v33
    v_mov_b32 v38, v34
    v_mov_b32 v39, v35
    v_add_u32 v31, 147456, v1
    s_lshl_b32 s78, s68, 3
    s_add_u32 s78, s78, 156160
    v_mov_b32 v30, s78
    s_add_u32 s85, s77, 4849664
    s_mul_i32 s99, s71, 1024
    s_add_u32 s85, s85, s99
    s_add_u32 s86, s77, 5283840
    s_mul_i32 s99, s69, 128
    s_add_u32 s86, s86, s99
    s_mul_i32 s99, s70, 8
    s_add_u32 s86, s86, s99
    s_cmp_eq_u32 s74, 0
    s_cbranch_scc1 L_nit0_56
    s_mov_b32 s8, s58
    s_mov_b32 s9, s59
    s_mov_b32 s10, 5242880
    s_mov_b32 s11, 0x20000
    s_mul_i32 s79, s70, 655360
    s_mul_i32 s99, s68, 163840
    s_add_u32 s79, s79, s99
    s_mul_i32 s99, s69, 256
    s_add_u32 s79, s79, s99
    v_lshrrev_b32 v62, 4, v0
    s_mov_b32 s99, 8192
    v_mul_lo_u32 v62, v62, s99
    v_and_b32 v63, 0xf0, v1
    v_add_u32 v62, v62, v63
    s_add_u32 s78, s79, 0
    buffer_load_dwordx4 a[204:207], v62, s[8:11], s78 offen nt
    s_add_u32 s78, s79, 32768
    buffer_load_dwordx4 a[208:211], v62, s[8:11], s78 offen nt
    s_add_u32 s78, s79, 65536
    buffer_load_dwordx4 a[212:215], v62, s[8:11], s78 offen nt
    s_add_u32 s78, s79, 98304
    buffer_load_dwordx4 a[216:219], v62, s[8:11], s78 offen nt
    s_add_u32 s78, s79, 131072
    buffer_load_dwordx4 a[220:223], v62, s[8:11], s78 offen nt
    s_waitcnt vmcnt(13)
    s_branch L_byit_57
L_nit0_56:
    s_mov_b32 s8, s58
    s_mov_b32 s9, s59
    s_mov_b32 s10, 5242880
    s_mov_b32 s11, 0x20000
    s_mul_i32 s79, s70, 655360
    s_mul_i32 s99, s68, 163840
    s_add_u32 s79, s79, s99
    s_mul_i32 s99, s69, 256
    s_add_u32 s79, s79, s99
    v_lshrrev_b32 v62, 4, v0
    s_mov_b32 s99, 8192
    v_mul_lo_u32 v62, v62, s99
    v_and_b32 v63, 0xf0, v1
    v_add_u32 v62, v62, v63
    s_add_u32 m0, s21, 0
    s_add_u32 s78, s79, 0
    buffer_load_dwordx4 v62, s[8:11], s78 offen nt lds
    s_add_u32 m0, s21, 1024
    s_add_u32 s78, s79, 32768
    buffer_load_dwordx4 v62, s[8:11], s78 offen nt lds
    s_add_u32 m0, s21, 2048
    s_add_u32 s78, s79, 65536
    buffer_load_dwordx4 v62, s[8:11], s78 offen nt lds
    s_add_u32 m0, s21, 3072
    s_add_u32 s78, s79, 98304
    buffer_load_dwordx4 v62, s[8:11], s78 offen nt lds
    s_add_u32 m0, s21, 4096
    s_add_u32 s78, s79, 131072
    buffer_load_dwordx4 v62, s[8:11], s78 offen nt lds
    s_waitcnt vmcnt(5)
L_byit_57:
    s_cmp_lg_u32 s68, 0
    s_cbranch_scc1 L_nohint_58
    s_cmp_lt_u32 s70, 5
    s_cbranch_scc1 L_nohint_58
L_hs_59:
    s_buffer_load_dword s80, s[4:7], s83 glc
    s_waitcnt lgkmcnt(0)
    s_cmp_lg_u32 s80, -1
    s_cbranch_scc1 L_hok_60
    s_sub_u32 s75, s75, 1
    s_cbranch_scc0 L_hs_59
    s_mov_b32 s75, 0
L_hok_60:
L_nohint_58:
    s_barrier
    buffer_load_dwordx4 v[8:11], v24, s[4:7], s81 offen sc1
    buffer_load_dwordx4 v[12:15], v24, s[4:7], s82 offen sc1
    s_cmp_eq_u32 s74, 0
    s_cbranch_scc1 L_nit0_64
    s_add_u32 s78, s76, 57344
    s_and_b32 s78, s78, 0xffff
    s_add_u32 s78, s78, s24
    s_add_u32 m0, s23, 8192
    s_nop 0
    buffer_load_dwordx4 v1, s[12:15], s78 offen offset:2048 nt lds
    s_add_u32 m0, s23, 8192
    s_nop 0
    buffer_load_dwordx4 v1, s[12:15], s78 offen offset:3072 nt lds
    s_add_u32 s78, s76, 61440
    s_and_b32 s78, s78, 0xffff
    s_add_u32 s78, s78, s24
    s_add_u32 m0, s23, 12288
    s_nop 0
    buffer_load_dwordx4 v1, s[12:15], s78 offen offset:0 nt lds
    s_add_u32 m0, s23, 12288
    s_nop 0
    buffer_load_dwordx4 v1, s[12:15], s78 offen offset:1024 nt lds
    s_add_u32 m0, s23, 12288
    s_nop 0
    buffer_load_dwordx4 v1, s[12:15], s78 offen offset:2048 nt lds
    s_add_u32 m0, s23, 12288
    s_nop 0
    buffer_load_dwordx4 v1, s[12:15], s78 offen offset:3072 nt lds
    s_add_u32 s78, s76, 0
    s_and_b32 s78, s78, 0xffff
    s_add_u32 s78, s78, s24
    buffer_load_dwordx4 a[0:3], v1, s[16:19], s78 offen offset:0 nt
    buffer_load_dwordx4 a[4:7], v1, s[16:19], s78 offen offset:1024 nt
    buffer_load_dwordx4 a[8:11], v1, s[16:19], s78 offen offset:2048 nt
    buffer_load_dwordx4 a[12:15], v1, s[16:19], s78 offen offset:3072 nt
    s_add_u32 s78, s76, 4096
    s_and_b32 s78, s78, 0xffff
    s_add_u32 s78, s78, s24
    buffer_load_dwordx4 a[16:19], v1, s[16:19], s78 offen offset:0 nt
    buffer_load_dwordx4 a[20:23], v1, s[16:19], s78 offen offset:1024 nt
    buffer_load_dwordx4 a[24:27], v1, s[16:19], s78 offen offset:2048 nt
    buffer_load_dwordx4 a[28:31], v1, s[16:19], s78 offen offset:3072 nt
    s_add_u32 s78, s76, 8192
    s_and_b32 s78, s78, 0xffff
    s_add_u32 s78, s78, s24
    buffer_load_dwordx4 a[32:35], v1, s[16:19], s78 offen offset:0 nt
    buffer_load_dwordx4 a[36:39], v1, s[16:19], s78 offen offset:1024 nt
    buffer_load_dwordx4 a[40:43], v1, s[16:19], s78 offen offset:2048 nt
    buffer_load_dwordx4 a[44:47], v1, s[16:19], s78 offen offset:3072 nt
    s_add_u32 s78, s76, 12288
    s_and_b32 s78, s78, 0xffff
    s_add_u32 s78, s78, s24
    buffer_load_dwordx4 a[48:51], v1, s[16:19], s78 offen offset:0 nt
    buffer_load_dwordx4 a[52:55], v1, s[16:19], s78 offen offset:1024 nt
    buffer_load_dwordx4 a[56:59], v1, s[16:19], s78 offen offset:2048 nt
    buffer_load_dwordx4 a[60:63], v1, s[16:19], s78 offen offset:3072 nt
    s_add_u32 s78, s76, 16384
    s_and_b32 s78, s78, 0xffff
    s_add_u32 s78, s78, s24
    buffer_load_dwordx4 a[64:67], v1, s[16:19], s78 offen offset:0 nt
    buffer_load_dwordx4 a[68:71], v1, s[16:19], s78 offen offset:1024 nt
    s_waitcnt vmcnt(24)
    s_branch L_chk_62_b
L_nit0_64:
    s_branch L_chk_62
L_retry_61:
    s_sub_u32 s75, s75, 1
    s_cbranch_scc0 L_retry_61_go
    s_mov_b32 s75, 0
    s_branch L_done_63
L_retry_61_go:
    buffer_load_dwordx4 v[8:11], v24, s[4:7], s81 offen sc1
    buffer_load_dwordx4 v[12:15], v24, s[4:7], s82 offen sc1
L_chk_62:
    s_waitcnt vmcnt(0)
L_chk_62_b:
    v_max3_u32 v19, v8, v9, v10
    v_max3_u32 v19, v19, v11, v12
    v_max3_u32 v19, v19, v13, v14
    v_max_u32 v19, v19, v15
    v_cmp_eq_u32 vcc, -1, v19
    s_nop 3
    s_cbranch_vccnz L_retry_61
L_done_63:
    s_cmp_eq_u32 s74, 0
    s_cbranch_scc1 L_nit0_65
    v_accvgpr_read_b32 v44, a204
    v_accvgpr_read_b32 v45, a205
    v_accvgpr_read_b32 v46, a206
    v_accvgpr_read_b32 v47, a207
    v_accvgpr_read_b32 v48, a208
    v_accvgpr_read_b32 v49, a209
    v_accvgpr_read_b32 v50, a210
    v_accvgpr_read_b32 v51, a211
    v_accvgpr_read_b32 v52, a212
    v_accvgpr_read_b32 v53, a213
    v_accvgpr_read_b32 v54, a214
    v_accvgpr_read_b32 v55, a215
    v_accvgpr_read_b32 v56, a216
    v_accvgpr_read_b32 v57, a217
    v_accvgpr_read_b32 v58, a218
    v_accvgpr_read_b32 v59, a219
    v_accvgpr_read_b32 v60, a220
    v_accvgpr_read_b32 v61, a221
    v_accvgpr_read_b32 v62, a222
    v_accvgpr_read_b32 v63, a223
    s_nop 0
    s_branch L_byit_66
L_nit0_65:
    v_add_u32 v26, s21, v1
    ds_read_b128 v[44:47], v26 offset:0
    ds_read_b128 v[48:51], v26 offset:1024
    ds_read_b128 v[52:55], v26 offset:2048
    ds_read_b128 v[56:59], v26 offset:3072
    ds_read_b128 v[60:63], v26 offset:4096
L_byit_66:
    v_mfma_f32_16x16x32_bf16 v[40:43], v[8:11], v[20:23], 0
    v_mfma_f32_16x16x32_bf16 v[40:43], v[12:15], v[20:23], v[40:43]
    s_nop 7
    ds_write_b32 v7, v40 offset:4096
    ds_write_b32 v7, v41 offset:4128
    ds_write_b32 v7, v42 offset:4160
    ds_write_b32 v7, v43 offset:4192
    s_waitcnt lgkmcnt(0)
    s_barrier
    ds_read_b32 v16, v27 offset:0
    ds_read_b32 v17, v27 offset:1024
    ds_read_b32 v18, v27 offset:2048
    ds_read_b32 v19, v27 offset:3072
    s_waitcnt lgkmcnt(0)
    v_pk_add_f32 v[16:17], v[16:17], v[18:19]
    v_add_f32 v16, v16, v17
    v_cvt_pk_bf16_f32 v16, v16, v16
    v_and_b32 v16, 0xffff0000, v16
    v_add_f32 v16, v6, v16
    v_cvt_pk_bf16_f32 v26, v16, v16
    v_and_b32 v6, v26, v25
    v_mov_b32 v28, v6
    v_mul_f32 v29, v6, v6
    v_and_b32_dpp v32, v26, v2 row_newbcast:0 row_mask:0xf bank_mask:0x3
    v_and_b32_dpp v33, v26, v3 row_newbcast:0 row_mask:0xf bank_mask:0x3
    v_and_b32_dpp v34, v26, v4 row_newbcast:0 row_mask:0xf bank_mask:0x3
    v_and_b32_dpp v35, v26, v5 row_newbcast:0 row_mask:0xf bank_mask:0x3
    v_and_b32_dpp v36, v26, v2 row_newbcast:1 row_mask:0xf bank_mask:0x3
    v_and_b32_dpp v37, v26, v3 row_newbcast:1 row_mask:0xf bank_mask:0x3
    v_and_b32_dpp v38, v26, v4 row_newbcast:1 row_mask:0xf bank_mask:0x3
    v_and_b32_dpp v39, v26, v5 row_newbcast:1 row_mask:0xf bank_mask:0x3
    v_mfma_f32_16x16x32_bf16 v[40:43], v[44:47], v[32:35], 0
    v_add_f32_dpp v28, v28, v28 row_ror:8 row_mask:0xf bank_mask:0xf
    v_add_f32_dpp v29, v29, v29 row_ror:8 row_mask:0xf bank_mask:0xf
    s_nop 0
    v_and_b32_dpp v32, v26, v2 row_newbcast:2 row_mask:0xf bank_mask:0x3
    v_and_b32_dpp v33, v26, v3 row_newbcast:2 row_mask:0xf bank_mask:0x3
    v_and_b32_dpp v34, v26, v4 row_newbcast:2 row_mask:0xf bank_mask:0x3
    v_and_b32_dpp v35, v26, v5 row_newbcast:2 row_mask:0xf bank_mask:0x3
    v_mfma_f32_16x16x32_bf16 v[40:43], v[48:51], v[36:39], v[40:43]
    v_add_f32_dpp v28, v28, v28 row_ror:4 row_mask:0xf bank_mask:0xf
    v_add_f32_dpp v29, v29, v29 row_ror:4 row_mask:0xf bank_mask:0xf
    s_nop 0
    v_and_b32_dpp v36, v26, v2 row_newbcast:3 row_mask:0xf bank_mask:0x3
    v_and_b32_dpp v37, v26, v3 row_newbcast:3 row_mask:0xf bank_mask:0x3
    v_and_b32_dpp v38, v26, v4 row_newbcast:3 row_mask:0xf bank_mask:0x3
    v_and_b32_dpp v39, v26, v5 row_newbcast:3 row_mask:0xf bank_mask:0x3
    v_mfma_f32_16x16x32_bf16 v[40:43], v[52:55], v[32:35], v[40:43]
    v_add_f32_dpp v28, v28, v28 row_ror:2 row_mask:0xf bank_mask:0xf
    v_add_f32_dpp v29, v29, v29 row_ror:2 row_mask:0xf bank_mask:0xf
    s_nop 0
    v_and_b32_dpp v32, v26, v2 row_newbcast:4 row_mask:0xf bank_mask:0x3
    v_and_b32_dpp v33, v26, v3 row_newbcast:4 row_mask:0xf bank_mask:0x3
    v_and_b32_dpp v34, v26, v4 row_newbcast:4 row_mask:0xf bank_mask:0x3
    v_and_b32_dpp v35, v26, v5 row_newbcast:4 row_mask:0xf bank_mask:0x3
    v_mfma_f32_16x16x32_bf16 v[40:43], v[56:59], v[36:39], v[40:43]
    v_add_f32_dpp v28, v28, v28 row_ror:1 row_mask:0xf bank_mask:0xf
    v_add_f32_dpp v29, v29, v29 row_ror:1 row_mask:0xf bank_mask:0xf
    s_nop 0
    v_add_f32_dpp v28, v28, v28 row_bcast:15 row_mask:0xa bank_mask:0xf
    v_add_f32_dpp v29, v29, v29 row_bcast:15 row_mask:0xa bank_mask:0xf
    v_mfma_f32_16x16x32_bf16 v[40:43], v[60:63], v[32:35], v[40:43]
    s_nop 0
    v_add_f32_dpp v28, v28, v28 row_bcast:31 row_mask:0xc bank_mask:0xf
    v_add_f32_dpp v29, v29, v29 row_bcast:31 row_mask:0xc bank_mask:0xf
    s_mov_b32 exec_lo, 0
    s_mov_b32 exec_hi, 0x80000000
    ds_write_b64 v30, v[28:29]
    s_mov_b64 exec, -1
    s_nop 0
    ds_write_b32 v7, v40 offset:0
    ds_write_b32 v7, v41 offset:32
    ds_write_b32 v7, v42 offset:64
    ds_write_b32 v7, v43 offset:96
    s_waitcnt lgkmcnt(0)
    s_barrier
    s_cmp_lg_u32 s68, 0
    s_cbranch_scc1 L_nw0_67
    ds_read_b128 v[8:11], v31 offset:0
    ds_read_b128 v[12:15], v31 offset:1024
    ds_read_b128 v[16:19], v31 offset:2048
    ds_read_b128 v[20:23], v31 offset:3072
    v_mov_b32 v30, 156160
    ds_read_b128 v[32:35], v30
    ds_read_b128 v[36:39], v30 offset:16
    s_waitcnt lgkmcnt(4)
    v_pk_add_f32 v[8:9], v[8:9], v[12:13]
    v_pk_add_f32 v[10:11], v[10:11], v[14:15]
    s_waitcnt lgkmcnt(2)
    v_pk_add_f32 v[16:17], v[16:17], v[20:21]
    v_pk_add_f32 v[18:19], v[18:19], v[22:23]
    v_pk_add_f32 v[8:9], v[8:9], v[16:17]
    v_pk_add_f32 v[10:11], v[10:11], v[18:19]
    s_waitcnt lgkmcnt(0)
    v_pk_add_f32 v[32:33], v[32:33], v[34:35]
    v_pk_add_f32 v[36:37], v[36:37], v[38:39]
    v_pk_add_f32 v[32:33], v[32:33], v[36:37]
    s_cmp_eq_u32 s34, 0
    s_cbranch_scc1 L_gst_68
    buffer_store_dwordx4 v[8:11], v1, s[4:7], s85 offen
    s_mov_b64 exec, 1
    buffer_store_dwordx2 v[32:33], off, s[4:7], s86
    s_mov_b64 exec, -1
    s_branch L_gste_69
L_gst_68:
    buffer_store_dwordx4 v[8:11], v1, s[4:7], s85 offen sc1
    s_mov_b64 exec, 1
    buffer_store_dwordx2 v[32:33], off, s[4:7], s86 sc1
    s_mov_b64 exec, -1
L_gste_69:
L_nw0_67:
    s_add_u32 s81, s77, 4849664
    s_mul_i32 s99, s69, 8192
    s_add_u32 s81, s81, s99
    s_add_u32 s82, s81, 4096
    s_add_u32 s83, s77, 5283840
    s_mul_i32 s99, s69, 128
    s_add_u32 s83, s83, s99
    v_and_b32 v42, 7, v0
    v_lshlrev_b32 v60, 2, v42
    v_lshlrev_b32 v42, 3, v42
    v_lshlrev_b32 v61, 3, v0
    v_add_u32 v61, 155648, v61
    v_and_b32 v62, 0xf0, v1
    v_add_u32 v62, 155648, v62
    s_cmp_eq_u32 s74, 0
    s_cbranch_scc1 L_nit0_70
    s_waitcnt vmcnt(10)
    s_branch L_gackk_71
L_nit0_70:
    s_cmp_eq_u32 s34, 0
    s_cbranch_scc1 L_gack_72
    s_waitcnt vmcnt(2)
    s_branch L_gack2_73
L_gack_72:
    s_waitcnt vmcnt(0)
L_gack2_73:
L_gackk_71:
    s_cmp_eq_u32 s68, 0
    s_cbranch_scc1 L_w0poll_75
    s_cmp_eq_u32 s74, 0
    s_cbranch_scc1 L_nit0_76
    s_add_u32 s78, s76, 16384
    s_and_b32 s78, s78, 0xffff
    s_add_u32 s78, s78, s24
    buffer_load_dwordx4 a[72:75], v1, s[16:19], s78 offen offset:2048 nt
    buffer_load_dwordx4 a[76:79], v1, s[16:19], s78 offen offset:3072 nt
    s_add_u32 s78, s76, 20480
    s_and_b32 s78, s78, 0xffff
    s_add_u32 s78, s78, s24
    buffer_load_dwordx4 a[80:83], v1, s[16:19], s78 offen offset:0 nt
    buffer_load_dwordx4 a[84:87], v1, s[16:19], s78 offen offset:1024 nt
    buffer_load_dwordx4 a[88:91], v1, s[16:19], s78 offen offset:2048 nt
    buffer_load_dwordx4 a[92:95], v1, s[16:19], s78 offen offset:3072 nt
    s_add_u32 s78, s76, 24576
    s_and_b32 s78, s78, 0xffff
    s_add_u32 s78, s78, s24
    buffer_load_dwordx4 a[96:99], v1, s[16:19], s78 offen offset:0 nt
    buffer_load_dwordx4 a[100:103], v1, s[16:19], s78 offen offset:1024 nt
    buffer_load_dwordx4 a[104:107], v1, s[16:19], s78 offen offset:2048 nt
    buffer_load_dwordx4 a[108:111], v1, s[16:19], s78 offen offset:3072 nt
    s_add_u32 s78, s76, 28672
    s_and_b32 s78, s78, 0xffff
    s_add_u32 s78, s78, s24
    buffer_load_dwordx4 a[112:115], v1, s[16:19], s78 offen offset:0 nt
    buffer_load_dwordx4 a[116:119], v1, s[16:19], s78 offen offset:1024 nt
    buffer_load_dwordx4 a[120:123], v1, s[16:19], s78 offen offset:2048 nt
    buffer_load_dwordx4 a[124:127], v1, s[16:19], s78 offen offset:3072 nt
    s_add_u32 s78, s76, 32768
    s_and_b32 s78, s78, 0xffff
    s_add_u32 s78, s78, s24
    buffer_load_dwordx4 a[128:131], v1, s[16:19], s78 offen offset:0 nt
    buffer_load_dwordx4 a[132:135], v1, s[16:19], s78 offen offset:1024 nt
    buffer_load_dwordx4 a[136:139], v1, s[16:19], s78 offen offset:2048 nt
    buffer_load_dwordx4 a[140:143], v1, s[16:19], s78 offen offset:3072 nt
    s_add_u32 s78, s76, 36864
    s_and_b32 s78, s78, 0xffff
    s_add_u32 s78, s78, s24
    buffer_load_dwordx4 a[144:147], v1, s[16:19], s78 offen offset:0 nt
    buffer_load_dwordx4 a[148:151], v1, s[16:19], s78 offen offset:1024 nt
    buffer_load_dwordx4 a[152:155], v1, s[16:19], s78 offen offset:2048 nt
    buffer_load_dwordx4 a[156:159], v1, s[16:19], s78 offen offset:3072 nt
    s_add_u32 s78, s76, 40960
    s_and_b32 s78, s78, 0xffff
    s_add_u32 s78, s78, s24
    buffer_load_dwordx4 a[160:163], v1, s[16:19], s78 offen offset:0 nt
    buffer_load_dwordx4 a[164:167], v1, s[16:19], s78 offen offset:1024 nt
L_nit0_76:
    s_branch L_nopoll_74
L_w0poll_75:
    buffer_load_dwordx4 v[8:11], v1, s[4:7], s81 offen offset:0 sc1
    buffer_load_dwordx4 v[12:15], v1, s[4:7], s81 offen offset:1024 sc1
    buffer_load_dwordx4 v[16:19], v1, s[4:7], s81 offen offset:2048 sc1
    buffer_load_dwordx4 v[20:23], v1, s[4:7], s81 offen offset:3072 sc1
    buffer_load_dwordx4 v[24:27], v1, s[4:7], s82 offen offset:0 sc1
    buffer_load_dwordx4 v[28:31], v1, s[4:7], s82 offen offset:1024 sc1
    buffer_load_dwordx4 v[32:35], v1, s[4:7], s82 offen offset:2048 sc1
    buffer_load_dwordx4 v[36:39], v1, s[4:7], s82 offen offset:3072 sc1
    buffer_load_dwordx2 v[40:41], v42, s[4:7], s83 offen sc1
    s_cmp_eq_u32 s74, 0
    s_cbranch_scc1 L_nit0_80
    s_add_u32 s78, s76, 16384
    s_and_b32 s78, s78, 0xffff
    s_add_u32 s78, s78, s24
    buffer_load_dwordx4 a[72:75], v1, s[16:19], s78 offen offset:2048 nt
    buffer_load_dwordx4 a[76:79], v1, s[16:19], s78 offen offset:3072 nt
    s_add_u32 s78, s76, 20480
    s_and_b32 s78, s78, 0xffff
    s_add_u32 s78, s78, s24
    buffer_load_dwordx4 a[80:83], v1, s[16:19], s78 offen offset:0 nt
    buffer_load_dwordx4 a[84:87], v1, s[16:19], s78 offen offset:1024 nt
    buffer_load_dwordx4 a[88:91], v1, s[16:19], s78 offen offset:2048 nt
    buffer_load_dwordx4 a[92:95], v1, s[16:19], s78 offen offset:3072 nt
    s_add_u32 s78, s76, 24576
    s_and_b32 s78, s78, 0xffff
    s_add_u32 s78, s78, s24
    buffer_load_dwordx4 a[96:99], v1, s[16:19], s78 offen offset:0 nt
    buffer_load_dwordx4 a[100:103], v1, s[16:19], s78 offen offset:1024 nt
    buffer_load_dwordx4 a[104:107], v1, s[16:19], s78 offen offset:2048 nt
    buffer_load_dwordx4 a[108:111], v1, s[16:19], s78 offen offset:3072 nt
    s_add_u32 s78, s76, 28672
    s_and_b32 s78, s78, 0xffff
    s_add_u32 s78, s78, s24
    buffer_load_dwordx4 a[112:115], v1, s[16:19], s78 offen offset:0 nt
    buffer_load_dwordx4 a[116:119], v1, s[16:19], s78 offen offset:1024 nt
    buffer_load_dwordx4 a[120:123], v1, s[16:19], s78 offen offset:2048 nt
    buffer_load_dwordx4 a[124:127], v1, s[16:19], s78 offen offset:3072 nt
    s_add_u32 s78, s76, 32768
    s_and_b32 s78, s78, 0xffff
    s_add_u32 s78, s78, s24
    buffer_load_dwordx4 a[128:131], v1, s[16:19], s78 offen offset:0 nt
    buffer_load_dwordx4 a[132:135], v1, s[16:19], s78 offen offset:1024 nt
    buffer_load_dwordx4 a[136:139], v1, s[16:19], s78 offen offset:2048 nt
    buffer_load_dwordx4 a[140:143], v1, s[16:19], s78 offen offset:3072 nt
    s_add_u32 s78, s76, 36864
    s_and_b32 s78, s78, 0xffff
    s_add_u32 s78, s78, s24
    buffer_load_dwordx4 a[144:147], v1, s[16:19], s78 offen offset:0 nt
    buffer_load_dwordx4 a[148:151], v1, s[16:19], s78 offen offset:1024 nt
    buffer_load_dwordx4 a[152:155], v1, s[16:19], s78 offen offset:2048 nt
    buffer_load_dwordx4 a[156:159], v1, s[16:19], s78 offen offset:3072 nt
    s_add_u32 s78, s76, 40960
    s_and_b32 s78, s78, 0xffff
    s_add_u32 s78, s78, s24
    buffer_load_dwordx4 a[160:163], v1, s[16:19], s78 offen offset:0 nt
    buffer_load_dwordx4 a[164:167], v1, s[16:19], s78 offen offset:1024 nt
    s_waitcnt vmcnt(24)
    s_branch L_chk_78_b
L_nit0_80:
    s_branch L_chk_78
L_retry_77:
    s_sub_u32 s75, s75, 1
    s_cbranch_scc0 L_retry_77_go
    s_mov_b32 s75, 0
    s_branch L_done_79
L_retry_77_go:
    buffer_load_dwordx4 v[8:11], v1, s[4:7], s81 offen offset:0 sc1
    buffer_load_dwordx4 v[12:15], v1, s[4:7], s81 offen offset:1024 sc1
    buffer_load_dwordx4 v[16:19], v1, s[4:7], s81 offen offset:2048 sc1
    buffer_load_dwordx4 v[20:23], v1, s[4:7], s81 offen offset:3072 sc1
    buffer_load_dwordx4 v[24:27], v1, s[4:7], s82 offen offset:0 sc1
    buffer_load_dwordx4 v[28:31], v1, s[4:7], s82 offen offset:1024 sc1
    buffer_load_dwordx4 v[32:35], v1, s[4:7], s82 offen offset:2048 sc1
    buffer_load_dwordx4 v[36:39], v1, s[4:7], s82 offen offset:3072 sc1
    buffer_load_dwordx2 v[40:41], v42, s[4:7], s83 offen sc1
L_chk_78:
    s_waitcnt vmcnt(0)
L_chk_78_b:
    v_pk_add_f32 v[8:9], v[8:9], v[24:25]
    v_pk_add_f32 v[10:11], v[10:11], v[26:27]
    v_pk_add_f32 v[12:13], v[12:13], v[28:29]
    v_pk_add_f32 v[14:15], v[14:15], v[30:31]
    v_pk_add_f32 v[16:17], v[16:17], v[32:33]
    v_pk_add_f32 v[18:19], v[18:19], v[34:35]
    v_pk_add_f32 v[20:21], v[20:21], v[36:37]
    v_pk_add_f32 v[22:23], v[22:23], v[38:39]
    v_pk_add_f32 v[8:9], v[8:9], v[16:17]
    v_pk_add_f32 v[10:11], v[10:11], v[18:19]
    v_pk_add_f32 v[12:13], v[12:13], v[20:21]
    v_pk_add_f32 v[14:15], v[14:15], v[22:23]
    v_pk_add_f32 v[8:9], v[8:9], v[12:13]
    v_pk_add_f32 v[10:11], v[10:11], v[14:15]
    v_add_f32 v12, v8, v9
    v_add_f32 v13, v10, v11
    v_add_f32 v14, v40, v41
    v_add_f32 v12, v12, v13
    v_add_f32 v12, v12, v14
    v_cmp_u_f32 vcc, v12, v12
    s_nop 3
    s_cbranch_vccnz L_retry_77
L_done_79:
    v_add_f32_dpp v40, v40, v40 quad_perm:[1,0,3,2] row_mask:0xf bank_mask:0xf
    v_add_f32_dpp v41, v41, v41 quad_perm:[1,0,3,2] row_mask:0xf bank_mask:0xf
    s_nop 0
    v_add_f32_dpp v40, v40, v40 quad_perm:[2,3,0,1] row_mask:0xf bank_mask:0xf
    v_add_f32_dpp v41, v41, v41 quad_perm:[2,3,0,1] row_mask:0xf bank_mask:0xf
    s_nop 0
    v_add_f32_dpp v40, v40, v40 row_half_mirror row_mask:0xf bank_mask:0xf
    v_add_f32_dpp v41, v41, v41 row_half_mirror row_mask:0xf bank_mask:0xf
    v_mul_f32 v40, 0x3acccccd, v40
    v_mul_f32 v41, 0x3acccccd, v41
    v_fma_f32 v41, -v40, v40, v41
    v_add_f32 v41, 0x3727c5ac, v41
    v_rsq_f32 v41, v41
    v_permlane32_swap_b32 v8, v12
    v_permlane32_swap_b32 v9, v13
    v_permlane32_swap_b32 v10, v14
    v_permlane32_swap_b32 v11, v15
    v_fma_f32 v8, -v40, v12, v8
    v_fma_f32 v9, -v40, v13, v9
    v_fma_f32 v10, -v40, v14, v10
    v_fma_f32 v11, -v40, v15, v11
    v_pk_mul_f32 v[8:9], v[8:9], v[40:41] op_sel:[0,1] op_sel_hi:[1,1]
    v_pk_mul_f32 v[10:11], v[10:11], v[40:41] op_sel:[0,1] op_sel_hi:[1,1]
    v_cvt_pk_bf16_f32 v12, v8, v9
    v_cvt_pk_bf16_f32 v13, v10, v11
    ds_write_b64 v61, v[12:13]
    s_waitcnt lgkmcnt(0)
L_nopoll_74:
    s_barrier
    ds_read_b128 v[8:11], v62
    v_add_u32 v60, s23, v1
    s_add_u32 s85, s77, 5111808
    s_mul_i32 s99, s71, 512
    s_add_u32 s85, s85, s99
    s_add_u32 s86, s77, 5287936
    s_mul_i32 s99, s69, 128
    s_add_u32 s86, s86, s99
    s_mul_i32 s99, s70, 8
    s_add_u32 s86, s86, s99
    s_cmp_lg_u32 s74, 0
    s_cbranch_scc1 L_nowo_81
    s_cmp_ge_u32 s70, 5
    s_cbranch_scc1 L_ns5_82
    s_mov_b32 s8, s60
    s_mov_b32 s9, s61
    s_mov_b32 s10, 5242880
    s_mov_b32 s11, 0x20000
    s_mul_i32 s79, s69, 163840
    s_mul_i32 s99, s68, 40960
    s_add_u32 s79, s79, s99
    s_mul_i32 s99, s70, 256
    s_add_u32 s79, s79, s99
    v_lshrrev_b32 v62, 4, v0
    s_mov_b32 s99, 1280
    v_mul_lo_u32 v62, v62, s99
    v_and_b32 v63, 0xf0, v1
    v_add_u32 v62, v62, v63
    s_add_u32 m0, s20, 0
    s_add_u32 s78, s79, 0
    buffer_load_dwordx4 v62, s[8:11], s78 offen nt lds
    s_add_u32 m0, s20, 1024
    s_add_u32 s78, s79, 5120
    buffer_load_dwordx4 v62, s[8:11], s78 offen nt lds
    s_add_u32 m0, s20, 2048
    s_add_u32 s78, s79, 10240
    buffer_load_dwordx4 v62, s[8:11], s78 offen nt lds
    s_add_u32 m0, s20, 3072
    s_add_u32 s78, s79, 15360
    buffer_load_dwordx4 v62, s[8:11], s78 offen nt lds
    s_add_u32 m0, s20, 4096
    s_add_u32 s78, s79, 20480
    buffer_load_dwordx4 v62, s[8:11], s78 offen nt lds
    s_add_u32 m0, s20, 5120
    s_add_u32 s78, s79, 25600
    buffer_load_dwordx4 v62, s[8:11], s78 offen nt lds
    s_add_u32 m0, s20, 6144
    s_add_u32 s78, s79, 30720
    buffer_load_dwordx4 v62, s[8:11], s78 offen nt lds
    s_add_u32 m0, s20, 7168
    s_add_u32 s78, s79, 35840
    buffer_load_dwordx4 v62, s[8:11], s78 offen nt lds
L_ns5_82:
L_nowo_81:
    s_cmp_eq_u32 s74, 0
    s_cbranch_scc1 L_nit0_83
    s_add_u32 s78, s76, 40960
    s_and_b32 s78, s78, 0xffff
    s_add_u32 s78, s78, s24
    buffer_load_dwordx4 a[168:171], v1, s[16:19], s78 offen offset:2048 nt
    buffer_load_dwordx4 a[172:175], v1, s[16:19], s78 offen offset:3072 nt
    s_add_u32 s78, s76, 45056
    s_and_b32 s78, s78, 0xffff
    s_add_u32 s78, s78, s24
    buffer_load_dwordx4 a[176:179], v1, s[16:19], s78 offen offset:0 nt
    buffer_load_dwordx4 a[180:183], v1, s[16:19], s78 offen offset:1024 nt
    buffer_load_dwordx4 a[184:187], v1, s[16:19], s78 offen offset:2048 nt
    buffer_load_dwordx4 a[188:191], v1, s[16:19], s78 offen offset:3072 nt
    s_waitcnt vmcnt(48)
L_nit0_83:
    ds_read_b128 v[28:31], v60 offset:0
    ds_read_b128 v[32:35], v60 offset:8192
    ds_read_b128 v[36:39], v60 offset:4096
    ds_read_b128 v[40:43], v60 offset:12288
    ds_read_b128 v[44:47], v60 offset:1024
    ds_read_b128 v[48:51], v60 offset:9216
    ds_read_b128 v[52:55], v60 offset:5120
    ds_read_b128 v[56:59], v60 offset:13312
    s_waitcnt lgkmcnt(4)
    v_dot2_f32_bf16 v12, v28, v8, 0
    v_dot2_f32_bf16 v13, v32, v8, 0
    v_dot2_f32_bf16 v14, v36, v8, 0
    v_dot2_f32_bf16 v15, v40, v8, 0
    v_dot2c_f32_bf16 v12, v29, v9
    v_dot2c_f32_bf16 v13, v33, v9
    v_dot2c_f32_bf16 v14, v37, v9
    v_dot2c_f32_bf16 v15, v41, v9
    v_dot2c_f32_bf16 v12, v30, v10
    v_dot2c_f32_bf16 v13, v34, v10
    v_dot2c_f32_bf16 v14, v38, v10
    v_dot2c_f32_bf16 v15, v42, v10
    v_dot2c_f32_bf16 v12, v31, v11
    v_dot2c_f32_bf16 v13, v35, v11
    v_dot2c_f32_bf16 v14, v39, v11
    v_dot2c_f32_bf16 v15, v43, v11
    ds_read_b128 v[28:31], v60 offset:2048
    ds_read_b128 v[32:35], v60 offset:10240
    ds_read_b128 v[36:39], v60 offset:6144
    ds_read_b128 v[40:43], v60 offset:14336
    s_waitcnt lgkmcnt(4)
    v_dot2_f32_bf16 v16, v44, v8, 0
    v_dot2_f32_bf16 v17, v48, v8, 0
    v_dot2_f32_bf16 v18, v52, v8, 0
    v_add_f32_dpp v20, v12, v12 row_ror:8 row_mask:0xf bank_mask:0x3
    v_dot2_f32_bf16 v19, v56, v8, 0
    v_add_f32_dpp v21, v14, v14 row_ror:8 row_mask:0xf bank_mask:0x3
    v_dot2c_f32_bf16 v16, v45, v9
    v_add_f32_dpp v20, v13, v13 row_ror:8 row_mask:0xf bank_mask:0xc
    v_dot2c_f32_bf16 v17, v49, v9
    v_add_f32_dpp v21, v15, v15 row_ror:8 row_mask:0xf bank_mask:0xc
    v_dot2c_f32_bf16 v18, v53, v9
    v_add_f32_dpp v22, v20, v20 row_shl:4 row_mask:0xf bank_mask:0x5
    v_dot2c_f32_bf16 v19, v57, v9
    s_nop 0
    v_add_f32_dpp v22, v21, v21 row_shr:4 row_mask:0xf bank_mask:0xa
    v_dot2c_f32_bf16 v16, v46, v10
    v_dot2c_f32_bf16 v17, v50, v10
    v_dot2c_f32_bf16 v18, v54, v10
    v_dot2c_f32_bf16 v19, v58, v10
    v_dot2c_f32_bf16 v16, v47, v11
    v_dot2c_f32_bf16 v17, v51, v11
    v_dot2c_f32_bf16 v18, v55, v11
    v_dot2c_f32_bf16 v19, v59, v11
    ds_read_b128 v[44:47], v60 offset:3072
    ds_read_b128 v[48:51], v60 offset:11264
    ds_read_b128 v[52:55], v60 offset:7168
    ds_read_b128 v[56:59], v60 offset:15360
    s_waitcnt lgkmcnt(4)
    v_dot2_f32_bf16 v12, v28, v8, 0
    v_dot2_f32_bf16 v13, v32, v8, 0
    v_dot2_f32_bf16 v14, v36, v8, 0
    v_add_f32_dpp v20, v16, v16 row_ror:8 row_mask:0xf bank_mask:0x3
    v_dot2_f32_bf16 v15, v40, v8, 0
    v_add_f32_dpp v21, v18, v18 row_ror:8 row_mask:0xf bank_mask:0x3
    v_dot2c_f32_bf16 v12, v29, v9
    v_add_f32_dpp v20, v17, v17 row_ror:8 row_mask:0xf bank_mask:0xc
    v_dot2c_f32_bf16 v13, v33, v9
    v_add_f32_dpp v21, v19, v19 row_ror:8 row_mask:0xf bank_mask:0xc
    v_dot2c_f32_bf16 v14, v37, v9
    v_add_f32_dpp v23, v20, v20 row_shl:4 row_mask:0xf bank_mask:0x5
    v_dot2c_f32_bf16 v15, v41, v9
    s_nop 0
    v_add_f32_dpp v23, v21, v21 row_shr:4 row_mask:0xf bank_mask:0xa
    v_dot2c_f32_bf16 v12, v30, v10
    v_dot2c_f32_bf16 v13, v34, v10
    v_dot2c_f32_bf16 v14, v38, v10
    v_dot2c_f32_bf16 v15, v42, v10
    v_dot2c_f32_bf16 v12, v31, v11
    v_dot2c_f32_bf16 v13, v35, v11
    v_dot2c_f32_bf16 v14, v39, v11
    v_dot2c_f32_bf16 v15, v43, v11
    s_waitcnt lgkmcnt(0)
    v_dot2_f32_bf16 v16, v44, v8, 0
    v_dot2_f32_bf16 v17, v48, v8, 0
    v_dot2_f32_bf16 v18, v52, v8, 0
    v_add_f32_dpp v20, v12, v12 row_ror:8 row_mask:0xf bank_mask:0x3
    v_dot2_f32_bf16 v19, v56, v8, 0
    v_add_f32_dpp v21, v14, v14 row_ror:8 row_mask:0xf bank_mask:0x3
    v_dot2c_f32_bf16 v16, v45, v9
    v_add_f32_dpp v20, v13, v13 row_ror:8 row_mask:0xf bank_mask:0xc
    v_dot2c_f32_bf16 v17, v49, v9
    v_add_f32_dpp v21, v15, v15 row_ror:8 row_mask:0xf bank_mask:0xc
    v_dot2c_f32_bf16 v18, v53, v9
    v_add_f32_dpp v24, v20, v20 row_shl:4 row_mask:0xf bank_mask:0x5
    v_dot2c_f32_bf16 v19, v57, v9
    s_nop 0
    v_add_f32_dpp v24, v21, v21 row_shr:4 row_mask:0xf bank_mask:0xa
    v_dot2c_f32_bf16 v16, v46, v10
    v_dot2c_f32_bf16 v17, v50, v10
    v_dot2c_f32_bf16 v18, v54, v10
    v_dot2c_f32_bf16 v19, v58, v10
    v_dot2c_f32_bf16 v16, v47, v11
    v_dot2c_f32_bf16 v17, v51, v11
    v_dot2c_f32_bf16 v18, v55, v11
    v_dot2c_f32_bf16 v19, v59, v11
    v_dot2_f32_bf16 v12, v64, v8, 0
    v_dot2_f32_bf16 v13, v96, v8, 0
    v_dot2_f32_bf16 v14, v80, v8, 0
    v_add_f32_dpp v20, v16, v16 row_ror:8 row_mask:0xf bank_mask:0x3
    v_dot2_f32_bf16 v15, v112, v8, 0
    v_add_f32_dpp v21, v18, v18 row_ror:8 row_mask:0xf bank_mask:0x3
    v_dot2c_f32_bf16 v12, v65, v9
    v_add_f32_dpp v20, v17, v17 row_ror:8 row_mask:0xf bank_mask:0xc
    v_dot2c_f32_bf16 v13, v97, v9
    v_add_f32_dpp v21, v19, v19 row_ror:8 row_mask:0xf bank_mask:0xc
    v_dot2c_f32_bf16 v14, v81, v9
    v_add_f32_dpp v25, v20, v20 row_shl:4 row_mask:0xf bank_mask:0x5
    v_dot2c_f32_bf16 v15, v113, v9
    s_nop 0
    v_add_f32_dpp v25, v21, v21 row_shr:4 row_mask:0xf bank_mask:0xa
    v_dot2c_f32_bf16 v12, v66, v10
    v_dot2c_f32_bf16 v13, v98, v10
    v_dot2c_f32_bf16 v14, v82, v10
    v_dot2c_f32_bf16 v15, v114, v10
    v_dot2c_f32_bf16 v12, v67, v11
    v_dot2c_f32_bf16 v13, v99, v11
    v_dot2c_f32_bf16 v14, v83, v11
    v_dot2c_f32_bf16 v15, v115, v11
    v_dot2_f32_bf16 v16, v68, v8, 0
    v_dot2_f32_bf16 v17, v100, v8, 0
    v_dot2_f32_bf16 v18, v84, v8, 0
    v_add_f32_dpp v36, v22, v22 quad_perm:[2,3,0,1] row_mask:0xf bank_mask:0xf
    v_dot2_f32_bf16 v19, v116, v8, 0
    v_add_f32_dpp v37, v24, v24 quad_perm:[2,3,0,1] row_mask:0xf bank_mask:0xf
    v_dot2c_f32_bf16 v16, v69, v9
    v_add_f32_dpp v38, v23, v23 quad_perm:[2,3,0,1] row_mask:0xf bank_mask:0xf
    v_dot2c_f32_bf16 v17, v101, v9
    v_add_f32_dpp v39, v25, v25 quad_perm:[2,3,0,1] row_mask:0xf bank_mask:0xf
    v_dot2c_f32_bf16 v18, v85, v9
    v_cndmask_b32 v26, v36, v37, s[26:27]
    v_dot2c_f32_bf16 v19, v117, v9
    v_cndmask_b32 v27, v38, v39, s[26:27]
    v_dot2c_f32_bf16 v16, v70, v10
    v_add_f32_dpp v36, v26, v26 quad_perm:[1,0,3,2] row_mask:0xf bank_mask:0xf
    v_dot2c_f32_bf16 v17, v102, v10
    v_add_f32_dpp v37, v27, v27 quad_perm:[1,0,3,2] row_mask:0xf bank_mask:0xf
    v_dot2c_f32_bf16 v18, v86, v10
    v_cndmask_b32 v35, v36, v37, s[28:29]
    v_dot2c_f32_bf16 v19, v118, v10
    v_add_f32_dpp v20, v12, v12 row_ror:8 row_mask:0xf bank_mask:0x3
    v_dot2c_f32_bf16 v16, v71, v11
    v_add_f32_dpp v21, v14, v14 row_ror:8 row_mask:0xf bank_mask:0x3
    v_dot2c_f32_bf16 v17, v103, v11
    v_add_f32_dpp v20, v13, v13 row_ror:8 row_mask:0xf bank_mask:0xc
    v_dot2c_f32_bf16 v18, v87, v11
    v_add_f32_dpp v21, v15, v15 row_ror:8 row_mask:0xf bank_mask:0xc
    v_dot2c_f32_bf16 v19, v119, v11
    v_add_f32_dpp v28, v20, v20 row_shl:4 row_mask:0xf bank_mask:0x5
    s_nop 1
    v_add_f32_dpp v28, v21, v21 row_shr:4 row_mask:0xf bank_mask:0xa
    v_dot2_f32_bf16 v12, v72, v8, 0
    v_dot2_f32_bf16 v13, v104, v8, 0
    v_dot2_f32_bf16 v14, v88, v8, 0
    v_add_f32_dpp v20, v16, v16 row_ror:8 row_mask:0xf bank_mask:0x3
    v_dot2_f32_bf16 v15, v120, v8, 0
    v_add_f32_dpp v21, v18, v18 row_ror:8 row_mask:0xf bank_mask:0x3
    v_dot2c_f32_bf16 v12, v73, v9
    v_add_f32_dpp v20, v17, v17 row_ror:8 row_mask:0xf bank_mask:0xc
    v_dot2c_f32_bf16 v13, v105, v9
    v_add_f32_dpp v21, v19, v19 row_ror:8 row_mask:0xf bank_mask:0xc
    v_dot2c_f32_bf16 v14, v89, v9
    v_add_f32_dpp v29, v20, v20 row_shl:4 row_mask:0xf bank_mask:0x5
    v_dot2c_f32_bf16 v15, v121, v9
    s_nop 0
    v_add_f32_dpp v29, v21, v21 row_shr:4 row_mask:0xf bank_mask:0xa
    v_dot2c_f32_bf16 v12, v74, v10
    v_dot2c_f32_bf16 v13, v106, v10
    v_dot2c_f32_bf16 v14, v90, v10
    v_dot2c_f32_bf16 v15, v122, v10
    v_dot2c_f32_bf16 v12, v75, v11
    v_dot2c_f32_bf16 v13, v107, v11
    v_dot2c_f32_bf16 v14, v91, v11
    v_dot2c_f32_bf16 v15, v123, v11
    v_dot2_f32_bf16 v16, v76, v8, 0
    v_dot2_f32_bf16 v17, v108, v8, 0
    v_dot2_f32_bf16 v18, v92, v8, 0
    v_add_f32_dpp v20, v12, v12 row_ror:8 row_mask:0xf bank_mask:0x3
    v_dot2_f32_bf16 v19, v124, v8, 0
    v_add_f32_dpp v21, v14, v14 row_ror:8 row_mask:0xf bank_mask:0x3
    v_dot2c_f32_bf16 v16, v77, v9
    v_add_f32_dpp v20, v13, v13 row_ror:8 row_mask:0xf bank_mask:0xc
    v_dot2c_f32_bf16 v17, v109, v9
    v_add_f32_dpp v21, v15, v15 row_ror:8 row_mask:0xf bank_mask:0xc
    v_dot2c_f32_bf16 v18, v93, v9
    v_add_f32_dpp v30, v20, v20 row_shl:4 row_mask:0xf bank_mask:0x5
    v_dot2c_f32_bf16 v19, v125, v9
    s_nop 0
    v_add_f32_dpp v30, v21, v21 row_shr:4 row_mask:0xf bank_mask:0xa
    v_dot2c_f32_bf16 v16, v78, v10
    v_dot2c_f32_bf16 v17, v110, v10
    v_dot2c_f32_bf16 v18, v94, v10
    v_dot2c_f32_bf16 v19, v126, v10
    v_dot2c_f32_bf16 v16, v79, v11
    v_dot2c_f32_bf16 v17, v111, v11
    v_dot2c_f32_bf16 v18, v95, v11
    v_dot2c_f32_bf16 v19, v127, v11
    v_dot2_f32_bf16 v12, v128, v8, 0
    v_dot2_f32_bf16 v13, v160, v8, 0
    v_dot2_f32_bf16 v14, v144, v8, 0
    v_add_f32_dpp v20, v16, v16 row_ror:8 row_mask:0xf bank_mask:0x3
    v_dot2_f32_bf16 v15, v176, v8, 0
    v_add_f32_dpp v21, v18, v18 row_ror:8 row_mask:0xf bank_mask:0x3
    v_dot2c_f32_bf16 v12, v129, v9
    v_add_f32_dpp v20, v17, v17 row_ror:8 row_mask:0xf bank_mask:0xc
    v_dot2c_f32_bf16 v13, v161, v9
    v_add_f32_dpp v21, v19, v19 row_ror:8 row_mask:0xf bank_mask:0xc
    v_dot2c_f32_bf16 v14, v145, v9
    v_add_f32_dpp v31, v20, v20 row_shl:4 row_mask:0xf bank_mask:0x5
    v_dot2c_f32_bf16 v15, v177, v9
    s_nop 0
    v_add_f32_dpp v31, v21, v21 row_shr:4 row_mask:0xf bank_mask:0xa
    v_dot2c_f32_bf16 v12, v130, v10
    v_dot2c_f32_bf16 v13, v162, v10
    v_dot2c_f32_bf16 v14, v146, v10
    v_dot2c_f32_bf16 v15, v178, v10
    v_dot2c_f32_bf16 v12, v131, v11
    v_dot2c_f32_bf16 v13, v163, v11
    v_dot2c_f32_bf16 v14, v147, v11
    v_dot2c_f32_bf16 v15, v179, v11
    v_dot2_f32_bf16 v16, v132, v8, 0
    v_dot2_f32_bf16 v17, v164, v8, 0
    v_dot2_f32_bf16 v18, v148, v8, 0
    v_add_f32_dpp v36, v28, v28 quad_perm:[2,3,0,1] row_mask:0xf bank_mask:0xf
    v_dot2_f32_bf16 v19, v180, v8, 0
    v_add_f32_dpp v37, v30, v30 quad_perm:[2,3,0,1] row_mask:0xf bank_mask:0xf
    v_dot2c_f32_bf16 v16, v133, v9
    v_add_f32_dpp v38, v29, v29 quad_perm:[2,3,0,1] row_mask:0xf bank_mask:0xf
    v_dot2c_f32_bf16 v17, v165, v9
    v_add_f32_dpp v39, v31, v31 quad_perm:[2,3,0,1] row_mask:0xf bank_mask:0xf
    v_dot2c_f32_bf16 v18, v149, v9
    v_cndmask_b32 v26, v36, v37, s[26:27]
    v_dot2c_f32_bf16 v19, v181, v9
    v_cndmask_b32 v27, v38, v39, s[26:27]
    v_dot2c_f32_bf16 v16, v134, v10
    v_add_f32_dpp v36, v26, v26 quad_perm:[1,0,3,2] row_mask:0xf bank_mask:0xf
    v_dot2c_f32_bf16 v17, v166, v10
    v_add_f32_dpp v37, v27, v27 quad_perm:[1,0,3,2] row_mask:0xf bank_mask:0xf
    v_dot2c_f32_bf16 v18, v150, v10
    v_cndmask_b32 v32, v36, v37, s[28:29]
    v_dot2c_f32_bf16 v19, v182, v10
    v_add_f32_dpp v20, v12, v12 row_ror:8 row_mask:0xf bank_mask:0x3
    v_dot2c_f32_bf16 v16, v135, v11
    v_add_f32_dpp v21, v14, v14 row_ror:8 row_mask:0xf bank_mask:0x3
    v_dot2c_f32_bf16 v17, v167, v11
    v_add_f32_dpp v20, v13, v13 row_ror:8 row_mask:0xf bank_mask:0xc
    v_dot2c_f32_bf16 v18, v151, v11
    v_add_f32_dpp v21, v15, v15 row_ror:8 row_mask:0xf bank_mask:0xc
    v_dot2c_f32_bf16 v19, v183, v11
    v_add_f32_dpp v22, v20, v20 row_shl:4 row_mask:0xf bank_mask:0x5
    s_nop 1
    v_add_f32_dpp v22, v21, v21 row_shr:4 row_mask:0xf bank_mask:0xa
    v_dot2_f32_bf16 v12, v136, v8, 0
    v_dot2_f32_bf16 v13, v168, v8, 0
    v_dot2_f32_bf16 v14, v152, v8, 0
    v_add_f32_dpp v20, v16, v16 row_ror:8 row_mask:0xf bank_mask:0x3
    v_dot2_f32_bf16 v15, v184, v8, 0
    v_add_f32_dpp v21, v18, v18 row_ror:8 row_mask:0xf bank_mask:0x3
    v_dot2c_f32_bf16 v12, v137, v9
    v_add_f32_dpp v20, v17, v17 row_ror:8 row_mask:0xf bank_mask:0xc
    v_dot2c_f32_bf16 v13, v169, v9
    v_add_f32_dpp v21, v19, v19 row_ror:8 row_mask:0xf bank_mask:0xc
    v_dot2c_f32_bf16 v14, v153, v9
    v_add_f32_dpp v23, v20, v20 row_shl:4 row_mask:0xf bank_mask:0x5
    v_dot2c_f32_bf16 v15, v185, v9
    s_nop 0
    v_add_f32_dpp v23, v21, v21 row_shr:4 row_mask:0xf bank_mask:0xa
    v_dot2c_f32_bf16 v12, v138, v10
    v_dot2c_f32_bf16 v13, v170, v10
    v_dot2c_f32_bf16 v14, v154, v10
    v_dot2c_f32_bf16 v15, v186, v10
    v_dot2c_f32_bf16 v12, v139, v11
    v_dot2c_f32_bf16 v13, v171, v11
    v_dot2c_f32_bf16 v14, v155, v11
    v_dot2c_f32_bf16 v15, v187, v11
    v_dot2_f32_bf16 v16, v140, v8, 0
    v_dot2_f32_bf16 v17, v172, v8, 0
    v_dot2_f32_bf16 v18, v156, v8, 0
    v_add_f32_dpp v20, v12, v12 row_ror:8 row_mask:0xf bank_mask:0x3
    v_dot2_f32_bf16 v19, v188, v8, 0
    v_add_f32_dpp v21, v14, v14 row_ror:8 row_mask:0xf bank_mask:0x3
    v_dot2c_f32_bf16 v16, v141, v9
    v_add_f32_dpp v20, v13, v13 row_ror:8 row_mask:0xf bank_mask:0xc
    v_dot2c_f32_bf16 v17, v173, v9
    v_add_f32_dpp v21, v15, v15 row_ror:8 row_mask:0xf bank_mask:0xc
    v_dot2c_f32_bf16 v18, v157, v9
    v_add_f32_dpp v24, v20, v20 row_shl:4 row_mask:0xf bank_mask:0x5
    v_dot2c_f32_bf16 v19, v189, v9
    s_nop 0
    v_add_f32_dpp v24, v21, v21 row_shr:4 row_mask:0xf bank_mask:0xa
    v_dot2c_f32_bf16 v16, v142, v10
    v_dot2c_f32_bf16 v17, v174, v10
    v_dot2c_f32_bf16 v18, v158, v10
    v_dot2c_f32_bf16 v19, v190, v10
    v_dot2c_f32_bf16 v16, v143, v11
    v_dot2c_f32_bf16 v17, v175, v11
    v_dot2c_f32_bf16 v18, v159, v11
    v_dot2c_f32_bf16 v19, v191, v11
    v_dot2_f32_bf16 v12, v192, v8, 0
    v_dot2_f32_bf16 v13, v224, v8, 0
    v_dot2_f32_bf16 v14, v208, v8, 0
    v_add_f32_dpp v20, v16, v16 row_ror:8 row_mask:0xf bank_mask:0x3
    v_dot2_f32_bf16 v15, v240, v8, 0
    v_add_f32_dpp v21, v18, v18 row_ror:8 row_mask:0xf bank_mask:0x3
    v_dot2c_f32_bf16 v12, v193, v9
    v_add_f32_dpp v20, v17, v17 row_ror:8 row_mask:0xf bank_mask:0xc
    v_dot2c_f32_bf16 v13, v225, v9
    v_add_f32_dpp v21, v19, v19 row_ror:8 row_mask:0xf bank_mask:0xc
    v_dot2c_f32_bf16 v14, v209, v9
    v_add_f32_dpp v25, v20, v20 row_shl:4 row_mask:0xf bank_mask:0x5
    v_dot2c_f32_bf16 v15, v241, v9
    s_nop 0
    v_add_f32_dpp v25, v21, v21 row_shr:4 row_mask:0xf bank_mask:0xa
    v_dot2c_f32_bf16 v12, v194, v10
    v_dot2c_f32_bf16 v13, v226, v10
    v_dot2c_f32_bf16 v14, v210, v10
    v_dot2c_f32_bf16 v15, v242, v10
    v_dot2c_f32_bf16 v12, v195, v11
    v_dot2c_f32_bf16 v13, v227, v11
    v_dot2c_f32_bf16 v14, v211, v11
    v_dot2c_f32_bf16 v15, v243, v11
    v_dot2_f32_bf16 v16, v196, v8, 0
    v_dot2_f32_bf16 v17, v228, v8, 0
    v_dot2_f32_bf16 v18, v212, v8, 0
    v_add_f32_dpp v36, v22, v22 quad_perm:[2,3,0,1] row_mask:0xf bank_mask:0xf
    v_dot2_f32_bf16 v19, v244, v8, 0
    v_add_f32_dpp v37, v24, v24 quad_perm:[2,3,0,1] row_mask:0xf bank_mask:0xf
    v_dot2c_f32_bf16 v16, v197, v9
    v_add_f32_dpp v38, v23, v23 quad_perm:[2,3,0,1] row_mask:0xf bank_mask:0xf
    v_dot2c_f32_bf16 v17, v229, v9
    v_add_f32_dpp v39, v25, v25 quad_perm:[2,3,0,1] row_mask:0xf bank_mask:0xf
    v_dot2c_f32_bf16 v18, v213, v9
    v_cndmask_b32 v26, v36, v37, s[26:27]
    v_dot2c_f32_bf16 v19, v245, v9
    v_cndmask_b32 v27, v38, v39, s[26:27]
    v_dot2c_f32_bf16 v16, v198, v10
    v_add_f32_dpp v36, v26, v26 quad_perm:[1,0,3,2] row_mask:0xf bank_mask:0xf
    v_dot2c_f32_bf16 v17, v230, v10
    v_add_f32_dpp v37, v27, v27 quad_perm:[1,0,3,2] row_mask:0xf bank_mask:0xf
    v_dot2c_f32_bf16 v18, v214, v10
    v_cndmask_b32 v33, v36, v37, s[28:29]
    v_dot2c_f32_bf16 v19, v246, v10
    v_add_f32_dpp v20, v12, v12 row_ror:8 row_mask:0xf bank_mask:0x3
    v_dot2c_f32_bf16 v16, v199, v11
    v_add_f32_dpp v21, v14, v14 row_ror:8 row_mask:0xf bank_mask:0x3
    v_dot2c_f32_bf16 v17, v231, v11
    v_add_f32_dpp v20, v13, v13 row_ror:8 row_mask:0xf bank_mask:0xc
    v_dot2c_f32_bf16 v18, v215, v11
    v_add_f32_dpp v21, v15, v15 row_ror:8 row_mask:0xf bank_mask:0xc
    v_dot2c_f32_bf16 v19, v247, v11
    v_add_f32_dpp v28, v20, v20 row_shl:4 row_mask:0xf bank_mask:0x5
    s_nop 1
    v_add_f32_dpp v28, v21, v21 row_shr:4 row_mask:0xf bank_mask:0xa
    v_dot2_f32_bf16 v12, v200, v8, 0
    v_dot2_f32_bf16 v13, v232, v8, 0
    v_dot2_f32_bf16 v14, v216, v8, 0
    v_add_f32_dpp v20, v16, v16 row_ror:8 row_mask:0xf bank_mask:0x3
    v_dot2_f32_bf16 v15, v248, v8, 0
    v_add_f32_dpp v21, v18, v18 row_ror:8 row_mask:0xf bank_mask:0x3
    v_dot2c_f32_bf16 v12, v201, v9
    v_add_f32_dpp v20, v17, v17 row_ror:8 row_mask:0xf bank_mask:0xc
    v_dot2c_f32_bf16 v13, v233, v9
    v_add_f32_dpp v21, v19, v19 row_ror:8 row_mask:0xf bank_mask:0xc
    v_dot2c_f32_bf16 v14, v217, v9
    v_add_f32_dpp v29, v20, v20 row_shl:4 row_mask:0xf bank_mask:0x5
    v_dot2c_f32_bf16 v15, v249, v9
    s_nop 0
    v_add_f32_dpp v29, v21, v21 row_shr:4 row_mask:0xf bank_mask:0xa
    v_dot2c_f32_bf16 v12, v202, v10
    v_dot2c_f32_bf16 v13, v234, v10
    v_dot2c_f32_bf16 v14, v218, v10
    v_dot2c_f32_bf16 v15, v250, v10
    v_dot2c_f32_bf16 v12, v203, v11
    v_dot2c_f32_bf16 v13, v235, v11
    v_dot2c_f32_bf16 v14, v219, v11
    v_dot2c_f32_bf16 v15, v251, v11
    v_dot2_f32_bf16 v16, v204, v8, 0
    v_dot2_f32_bf16 v17, v236, v8, 0
    v_dot2_f32_bf16 v18, v220, v8, 0
    v_add_f32_dpp v20, v12, v12 row_ror:8 row_mask:0xf bank_mask:0x3
    v_dot2_f32_bf16 v19, v252, v8, 0
    v_add_f32_dpp v21, v14, v14 row_ror:8 row_mask:0xf bank_mask:0x3
    v_dot2c_f32_bf16 v16, v205, v9
    v_add_f32_dpp v20, v13, v13 row_ror:8 row_mask:0xf bank_mask:0xc
    v_dot2c_f32_bf16 v17, v237, v9
    v_add_f32_dpp v21, v15, v15 row_ror:8 row_mask:0xf bank_mask:0xc
    v_dot2c_f32_bf16 v18, v221, v9
    v_add_f32_dpp v30, v20, v20 row_shl:4 row_mask:0xf bank_mask:0x5
    v_dot2c_f32_bf16 v19, v253, v9
    s_nop 0
    v_add_f32_dpp v30, v21, v21 row_shr:4 row_mask:0xf bank_mask:0xa
    v_dot2c_f32_bf16 v16, v206, v10
    v_dot2c_f32_bf16 v17, v238, v10
    v_dot2c_f32_bf16 v18, v222, v10
    v_dot2c_f32_bf16 v19, v254, v10
    v_dot2c_f32_bf16 v16, v207, v11
    v_dot2c_f32_bf16 v17, v239, v11
    v_dot2c_f32_bf16 v18, v223, v11
    v_dot2c_f32_bf16 v19, v255, v11
    v_add_f32_dpp v20, v16, v16 row_ror:8 row_mask:0xf bank_mask:0x3
    s_nop 0
    v_add_f32_dpp v21, v18, v18 row_ror:8 row_mask:0xf bank_mask:0x3
    v_add_f32_dpp v20, v17, v17 row_ror:8 row_mask:0xf bank_mask:0xc
    s_nop 0
    v_add_f32_dpp v21, v19, v19 row_ror:8 row_mask:0xf bank_mask:0xc
    v_add_f32_dpp v31, v20, v20 row_shl:4 row_mask:0xf bank_mask:0x5
    s_nop 1
    v_add_f32_dpp v31, v21, v21 row_shr:4 row_mask:0xf bank_mask:0xa
    v_add_f32_dpp v36, v28, v28 quad_perm:[2,3,0,1] row_mask:0xf bank_mask:0xf
    v_add_f32_dpp v37, v30, v30 quad_perm:[2,3,0,1] row_mask:0xf bank_mask:0xf
    v_add_f32_dpp v38, v29, v29 quad_perm:[2,3,0,1] row_mask:0xf bank_mask:0xf
    v_add_f32_dpp v39, v31, v31 quad_perm:[2,3,0,1] row_mask:0xf bank_mask:0xf
    v_cndmask_b32 v26, v36, v37, s[26:27]
    v_cndmask_b32 v27, v38, v39, s[26:27]
    s_nop 0
    v_add_f32_dpp v36, v26, v26 quad_perm:[1,0,3,2] row_mask:0xf bank_mask:0xf
    v_add_f32_dpp v37, v27, v27 quad_perm:[1,0,3,2] row_mask:0xf bank_mask:0xf
    v_cndmask_b32 v34, v36, v37, s[28:29]
    v_max3_f32 v36, v32, v33, v34
    v_max_f32 v36, v36, v35
    s_nop 1
    v_max_f32_dpp v36, v36, v36 row_ror:8 row_mask:0xf bank_mask:0xf
    v_and_b32 v15, 3, v0
    v_lshlrev_b32 v16, 4, v15
    v_max_f32_dpp v36, v36, v36 row_ror:4 row_mask:0xf bank_mask:0xf
    v_mov_b32 v17, 0xffff
    v_lshlrev_b32 v12, v16, v17
    v_max_f32_dpp v36, v36, v36 row_ror:2 row_mask:0xf bank_mask:0xf
    v_cmp_gt_u32 vcc, 2, v15
    v_mov_b32 v13, v12
    v_max_f32_dpp v36, v36, v36 row_ror:1 row_mask:0xf bank_mask:0xf
    s_nop 0
    v_cndmask_b32 v12, 0, v12, vcc
    v_cndmask_b32 v13, v13, 0, vcc
    v_mov_b32 v37, v36
    s_nop 1
    v_permlane32_swap_b32 v36, v37
    v_max_f32 v36, v36, v37
    v_mov_b32 v37, v36
    s_nop 1
    v_permlane16_swap_b32 v36, v37
    v_max_f32 v36, v36, v37
    v_mul_f32 v36, s32, v36
    v_fma_f32 v32, v32, s32, -v36
    v_fma_f32 v33, v33, s32, -v36
    v_fma_f32 v34, v34, s32, -v36
    v_fma_f32 v35, v35, s32, -v36
    v_exp_f32 v32, v32
    v_exp_f32 v33, v33
    v_exp_f32 v34, v34
    v_exp_f32 v35, v35
    v_bfe_u32 v14, v0, 2, 2
    v_lshlrev_b32 v14, 5, v14
    v_bfe_u32 v16, v0, 4, 1
    v_lshl_add_u32 v14, v16, 3, v14
    v_bfe_u32 v16, v0, 5, 1
    v_lshl_add_u32 v14, v16, 2, v14
    v_add_u32 v14, v14, v15
    v_lshlrev_b32 v14, 2, v14
    s_lshl_b32 s78, s68, 10
    s_add_u32 s78, s78, 151552
    v_add_u32 v14, s78, v14
    v_add_f32 v37, v32, v33
    v_add_f32 v38, v34, v35
    v_add_f32 v37, v37, v38
    v_cvt_pk_bf16_f32 v32, v32, v32
    v_cvt_pk_bf16_f32 v33, v33, v33
    v_cvt_pk_bf16_f32 v34, v34, v34
    v_cvt_pk_bf16_f32 v35, v35, v35
    s_cmp_eq_u32 s74, 0
    s_cbranch_scc1 L_nit0_84
    s_add_u32 s78, s76, 49152
    s_and_b32 s78, s78, 0xffff
    s_add_u32 s78, s78, s24
    buffer_load_dwordx4 a[192:195], v1, s[16:19], s78 offen offset:0 nt
    buffer_load_dwordx4 a[196:199], v1, s[16:19], s78 offen offset:1024 nt
    buffer_load_dwordx4 a[200:203], v1, s[16:19], s78 offen offset:2048 nt
    buffer_load_dwordx4 a[204:207], v1, s[16:19], s78 offen offset:3072 nt
    s_add_u32 s78, s76, 53248
    s_and_b32 s78, s78, 0xffff
    s_add_u32 s78, s78, s24
    buffer_load_dwordx4 a[208:211], v1, s[16:19], s78 offen offset:0 nt
    buffer_load_dwordx4 a[212:215], v1, s[16:19], s78 offen offset:1024 nt
    buffer_load_dwordx4 a[216:219], v1, s[16:19], s78 offen offset:2048 nt
    buffer_load_dwordx4 a[220:223], v1, s[16:19], s78 offen offset:3072 nt
    s_add_u32 s78, s76, 57344
    s_and_b32 s78, s78, 0xffff
    s_add_u32 s78, s78, s24
    buffer_load_dwordx4 a[224:227], v1, s[16:19], s78 offen offset:0 nt
    buffer_load_dwordx4 a[228:231], v1, s[16:19], s78 offen offset:1024 nt
    buffer_load_dwordx4 a[232:235], v1, s[16:19], s78 offen offset:2048 nt
    buffer_load_dwordx4 a[236:239], v1, s[16:19], s78 offen offset:3072 nt
    s_add_u32 s78, s76, 61440
    s_and_b32 s78, s78, 0xffff
    s_add_u32 s78, s78, s24
    buffer_load_dwordx4 a[240:243], v1, s[16:19], s78 offen offset:0 nt
    buffer_load_dwordx4 a[244:247], v1, s[16:19], s78 offen offset:1024 nt
    buffer_load_dwordx4 a[248:251], v1, s[16:19], s78 offen offset:2048 nt
    buffer_load_dwordx4 a[252:255], v1, s[16:19], s78 offen offset:3072 nt
    s_mov_b32 s8, s46
    s_mov_b32 s9, s47
    s_mov_b32 s10, 4194304
    s_mov_b32 s11, 0x20000
    s_mul_i32 s79, s70, 524288
    s_mul_i32 s99, s68, 131072
    s_add_u32 s79, s79, s99
    s_mul_i32 s99, s69, 256
    s_add_u32 s79, s79, s99
    v_lshrrev_b32 v62, 4, v0
    s_mov_b32 s99, 32768
    v_mul_lo_u32 v62, v62, s99
    v_and_b32 v63, 0xf0, v1
    v_add_u32 v62, v62, v63
    s_add_u32 m0, s22, 0
    s_add_u32 s78, s79, 0
    buffer_load_dwordx4 v62, s[8:11], s78 offen nt lds
    s_add_u32 m0, s22, 1024
    s_add_u32 s78, s79, 8192
    buffer_load_dwordx4 v62, s[8:11], s78 offen nt lds
    s_add_u32 m0, s22, 2048
    s_add_u32 s78, s79, 16384
    buffer_load_dwordx4 v62, s[8:11], s78 offen nt lds
    s_add_u32 m0, s22, 3072
    s_add_u32 s78, s79, 24576
    buffer_load_dwordx4 v62, s[8:11], s78 offen nt lds
L_nit0_84:
    v_and_b32_dpp v40, v32, v12 row_newbcast:0 row_mask:0xf bank_mask:0xf
    v_and_b32_dpp v41, v32, v13 row_newbcast:0 row_mask:0xf bank_mask:0xf
    v_and_b32_dpp v42, v32, v12 row_newbcast:1 row_mask:0xf bank_mask:0xf
    v_and_b32_dpp v43, v32, v13 row_newbcast:1 row_mask:0xf bank_mask:0xf
    s_waitcnt vmcnt(63)
    v_mfma_f32_4x4x4bf16_1k v[48:51], a[0:1], v[40:41], 0
    v_mfma_f32_4x4x4bf16_1k v[52:55], a[2:3], v[40:41], 0
    v_add_f32_dpp v37, v37, v37 row_ror:8 row_mask:0xf bank_mask:0xf
    v_and_b32_dpp v40, v32, v12 row_newbcast:2 row_mask:0xf bank_mask:0xf
    v_and_b32_dpp v41, v32, v13 row_newbcast:2 row_mask:0xf bank_mask:0xf
    v_mfma_f32_4x4x4bf16_1k v[48:51], a[4:5], v[42:43], v[48:51]
    v_mfma_f32_4x4x4bf16_1k v[52:55], a[6:7], v[42:43], v[52:55]
    v_add_f32_dpp v37, v37, v37 row_ror:4 row_mask:0xf bank_mask:0xf
    v_and_b32_dpp v42, v32, v12 row_newbcast:3 row_mask:0xf bank_mask:0xf
    v_and_b32_dpp v43, v32, v13 row_newbcast:3 row_mask:0xf bank_mask:0xf
    v_mfma_f32_4x4x4bf16_1k v[48:51], a[8:9], v[40:41], v[48:51]
    v_mfma_f32_4x4x4bf16_1k v[52:55], a[10:11], v[40:41], v[52:55]
    v_add_f32_dpp v37, v37, v37 row_ror:2 row_mask:0xf bank_mask:0xf
    v_and_b32_dpp v40, v32, v12 row_newbcast:4 row_mask:0xf bank_mask:0xf
    v_and_b32_dpp v41, v32, v13 row_newbcast:4 row_mask:0xf bank_mask:0xf
    v_mfma_f32_4x4x4bf16_1k v[48:51], a[12:13], v[42:43], v[48:51]
    v_mfma_f32_4x4x4bf16_1k v[52:55], a[14:15], v[42:43], v[52:55]
    v_add_f32_dpp v37, v37, v37 row_ror:1 row_mask:0xf bank_mask:0xf
    v_and_b32_dpp v42, v32, v12 row_newbcast:5 row_mask:0xf bank_mask:0xf
    v_and_b32_dpp v43, v32, v13 row_newbcast:5 row_mask:0xf bank_mask:0xf
    s_waitcnt vmcnt(60)
    v_mfma_f32_4x4x4bf16_1k v[48:51], a[16:17], v[40:41], v[48:51]
    v_mfma_f32_4x4x4bf16_1k v[52:55], a[18:19], v[40:41], v[52:55]
    v_and_b32_dpp v40, v32, v12 row_newbcast:6 row_mask:0xf bank_mask:0xf
    v_and_b32_dpp v41, v32, v13 row_newbcast:6 row_mask:0xf bank_mask:0xf
    v_mfma_f32_4x4x4bf16_1k v[48:51], a[20:21], v[42:43], v[48:51]
    v_mfma_f32_4x4x4bf16_1k v[52:55], a[22:23], v[42:43], v[52:55]
    v_and_b32_dpp v42, v32, v12 row_newbcast:7 row_mask:0xf bank_mask:0xf
    v_and_b32_dpp v43, v32, v13 row_newbcast:7 row_mask:0xf bank_mask:0xf
    v_mfma_f32_4x4x4bf16_1k v[48:51], a[24:25], v[40:41], v[48:51]
    v_mfma_f32_4x4x4bf16_1k v[52:55], a[26:27], v[40:41], v[52:55]
    v_and_b32_dpp v40, v32, v12 row_newbcast:8 row_mask:0xf bank_mask:0xf
    v_and_b32_dpp v41, v32, v13 row_newbcast:8 row_mask:0xf bank_mask:0xf
    v_mfma_f32_4x4x4bf16_1k v[48:51], a[28:29], v[42:43], v[48:51]
    v_mfma_f32_4x4x4bf16_1k v[52:55], a[30:31], v[42:43], v[52:55]
    v_and_b32_dpp v42, v32, v12 row_newbcast:9 row_mask:0xf bank_mask:0xf
    v_and_b32_dpp v43, v32, v13 row_newbcast:9 row_mask:0xf bank_mask:0xf
    s_waitcnt vmcnt(56)
    v_mfma_f32_4x4x4bf16_1k v[48:51], a[32:33], v[40:41], v[48:51]
    v_mfma_f32_4x4x4bf16_1k v[52:55], a[34:35], v[40:41], v[52:55]
    v_and_b32_dpp v40, v32, v12 row_newbcast:10 row_mask:0xf bank_mask:0xf
    v_and_b32_dpp v41, v32, v13 row_newbcast:10 row_mask:0xf bank_mask:0xf
    v_mfma_f32_4x4x4bf16_1k v[48:51], a[36:37], v[42:43], v[48:51]
    v_mfma_f32_4x4x4bf16_1k v[52:55], a[38:39], v[42:43], v[52:55]
    v_and_b32_dpp v42, v32, v12 row_newbcast:11 row_mask:0xf bank_mask:0xf
    v_and_b32_dpp v43, v32, v13 row_newbcast:11 row_mask:0xf bank_mask:0xf
    v_mfma_f32_4x4x4bf16_1k v[48:51], a[40:41], v[40:41], v[48:51]
    v_mfma_f32_4x4x4bf16_1k v[52:55], a[42:43], v[40:41], v[52:55]
    v_and_b32_dpp v40, v32, v12 row_newbcast:12 row_mask:0xf bank_mask:0xf
    v_and_b32_dpp v41, v32, v13 row_newbcast:12 row_mask:0xf bank_mask:0xf
    v_mfma_f32_4x4x4bf16_1k v[48:51], a[44:45], v[42:43], v[48:51]
    v_mfma_f32_4x4x4bf16_1k v[52:55], a[46:47], v[42:43], v[52:55]
    v_and_b32_dpp v42, v32, v12 row_newbcast:13 row_mask:0xf bank_mask:0xf
    v_and_b32_dpp v43, v32, v13 row_newbcast:13 row_mask:0xf bank_mask:0xf
    s_waitcnt vmcnt(52)
    v_mfma_f32_4x4x4bf16_1k v[48:51], a[48:49], v[40:41], v[48:51]
    v_mfma_f32_4x4x4bf16_1k v[52:55], a[50:51], v[40:41], v[52:55]
    v_and_b32_dpp v40, v32, v12 row_newbcast:14 row_mask:0xf bank_mask:0xf
    v_and_b32_dpp v41, v32, v13 row_newbcast:14 row_mask:0xf bank_mask:0xf
    v_mfma_f32_4x4x4bf16_1k v[48:51], a[52:53], v[42:43], v[48:51]
    v_mfma_f32_4x4x4bf16_1k v[52:55], a[54:55], v[42:43], v[52:55]
    v_and_b32_dpp v42, v32, v12 row_newbcast:15 row_mask:0xf bank_mask:0xf
    v_and_b32_dpp v43, v32, v13 row_newbcast:15 row_mask:0xf bank_mask:0xf
    v_mfma_f32_4x4x4bf16_1k v[48:51], a[56:57], v[40:41], v[48:51]
    v_mfma_f32_4x4x4bf16_1k v[52:55], a[58:59], v[40:41], v[52:55]
    v_and_b32_dpp v40, v33, v12 row_newbcast:0 row_mask:0xf bank_mask:0xf
    v_and_b32_dpp v41, v33, v13 row_newbcast:0 row_mask:0xf bank_mask:0xf
    v_mfma_f32_4x4x4bf16_1k v[48:51], a[60:61], v[42:43], v[48:51]
    v_mfma_f32_4x4x4bf16_1k v[52:55], a[62:63], v[42:43], v[52:55]
    v_and_b32_dpp v42, v33, v12 row_newbcast:1 row_mask:0xf bank_mask:0xf
    v_and_b32_dpp v43, v33, v13 row_newbcast:1 row_mask:0xf bank_mask:0xf
    s_waitcnt vmcnt(48)
    v_mfma_f32_4x4x4bf16_1k v[48:51], a[64:65], v[40:41], v[48:51]
    v_mfma_f32_4x4x4bf16_1k v[52:55], a[66:67], v[40:41], v[52:55]
    v_and_b32_dpp v40, v33, v12 row_newbcast:2 row_mask:0xf bank_mask:0xf
    v_and_b32_dpp v41, v33, v13 row_newbcast:2 row_mask:0xf bank_mask:0xf
    v_mfma_f32_4x4x4bf16_1k v[48:51], a[68:69], v[42:43], v[48:51]
    v_mfma_f32_4x4x4bf16_1k v[52:55], a[70:71], v[42:43], v[52:55]
    v_and_b32_dpp v42, v33, v12 row_newbcast:3 row_mask:0xf bank_mask:0xf
    v_and_b32_dpp v43, v33, v13 row_newbcast:3 row_mask:0xf bank_mask:0xf
    v_mfma_f32_4x4x4bf16_1k v[48:51], a[72:73], v[40:41], v[48:51]
    v_mfma_f32_4x4x4bf16_1k v[52:55], a[74:75], v[40:41], v[52:55]
    v_and_b32_dpp v40, v33, v12 row_newbcast:4 row_mask:0xf bank_mask:0xf
    v_and_b32_dpp v41, v33, v13 row_newbcast:4 row_mask:0xf bank_mask:0xf
    v_mfma_f32_4x4x4bf16_1k v[48:51], a[76:77], v[42:43], v[48:51]
    v_mfma_f32_4x4x4bf16_1k v[52:55], a[78:79], v[42:43], v[52:55]
    v_and_b32_dpp v42, v33, v12 row_newbcast:5 row_mask:0xf bank_mask:0xf
    v_and_b32_dpp v43, v33, v13 row_newbcast:5 row_mask:0xf bank_mask:0xf
    s_waitcnt vmcnt(44)
    v_mfma_f32_4x4x4bf16_1k v[48:51], a[80:81], v[40:41], v[48:51]
    v_mfma_f32_4x4x4bf16_1k v[52:55], a[82:83], v[40:41], v[52:55]
    v_and_b32_dpp v40, v33, v12 row_newbcast:6 row_mask:0xf bank_mask:0xf
    v_and_b32_dpp v41, v33, v13 row_newbcast:6 row_mask:0xf bank_mask:0xf
    v_mfma_f32_4x4x4bf16_1k v[48:51], a[84:85], v[42:43], v[48:51]
    v_mfma_f32_4x4x4bf16_1k v[52:55], a[86:87], v[42:43], v[52:55]
    v_and_b32_dpp v42, v33, v12 row_newbcast:7 row_mask:0xf bank_mask:0xf
    v_and_b32_dpp v43, v33, v13 row_newbcast:7 row_mask:0xf bank_mask:0xf
    v_mfma_f32_4x4x4bf16_1k v[48:51], a[88:89], v[40:41], v[48:51]
    v_mfma_f32_4x4x4bf16_1k v[52:55], a[90:91], v[40:41], v[52:55]
    v_and_b32_dpp v40, v33, v12 row_newbcast:8 row_mask:0xf bank_mask:0xf
    v_and_b32_dpp v41, v33, v13 row_newbcast:8 row_mask:0xf bank_mask:0xf
    v_mfma_f32_4x4x4bf16_1k v[48:51], a[92:93], v[42:43], v[48:51]
    v_mfma_f32_4x4x4bf16_1k v[52:55], a[94:95], v[42:43], v[52:55]
    v_and_b32_dpp v42, v33, v12 row_newbcast:9 row_mask:0xf bank_mask:0xf
    v_and_b32_dpp v43, v33, v13 row_newbcast:9 row_mask:0xf bank_mask:0xf
    s_waitcnt vmcnt(40)
    v_mfma_f32_4x4x4bf16_1k v[48:51], a[96:97], v[40:41], v[48:51]
    v_mfma_f32_4x4x4bf16_1k v[52:55], a[98:99], v[40:41], v[52:55]
    v_and_b32_dpp v40, v33, v12 row_newbcast:10 row_mask:0xf bank_mask:0xf
    v_and_b32_dpp v41, v33, v13 row_newbcast:10 row_mask:0xf bank_mask:0xf
    v_mfma_f32_4x4x4bf16_1k v[48:51], a[100:101], v[42:43], v[48:51]
    v_mfma_f32_4x4x4bf16_1k v[52:55], a[102:103], v[42:43], v[52:55]
    v_and_b32_dpp v42, v33, v12 row_newbcast:11 row_mask:0xf bank_mask:0xf
    v_and_b32_dpp v43, v33, v13 row_newbcast:11 row_mask:0xf bank_mask:0xf
    v_mfma_f32_4x4x4bf16_1k v[48:51], a[104:105], v[40:41], v[48:51]
    v_mfma_f32_4x4x4bf16_1k v[52:55], a[106:107], v[40:41], v[52:55]
    v_and_b32_dpp v40, v33, v12 row_newbcast:12 row_mask:0xf bank_mask:0xf
    v_and_b32_dpp v41, v33, v13 row_newbcast:12 row_mask:0xf bank_mask:0xf
    v_mfma_f32_4x4x4bf16_1k v[48:51], a[108:109], v[42:43], v[48:51]
    v_mfma_f32_4x4x4bf16_1k v[52:55], a[110:111], v[42:43], v[52:55]
    v_and_b32_dpp v42, v33, v12 row_newbcast:13 row_mask:0xf bank_mask:0xf
    v_and_b32_dpp v43, v33, v13 row_newbcast:13 row_mask:0xf bank_mask:0xf
    s_waitcnt vmcnt(36)
    v_mfma_f32_4x4x4bf16_1k v[48:51], a[112:113], v[40:41], v[48:51]
    v_mfma_f32_4x4x4bf16_1k v[52:55], a[114:115], v[40:41], v[52:55]
    v_and_b32_dpp v40, v33, v12 row_newbcast:14 row_mask:0xf bank_mask:0xf
    v_and_b32_dpp v41, v33, v13 row_newbcast:14 row_mask:0xf bank_mask:0xf
    v_mfma_f32_4x4x4bf16_1k v[48:51], a[116:117], v[42:43], v[48:51]
    v_mfma_f32_4x4x4bf16_1k v[52:55], a[118:119], v[42:43], v[52:55]
    v_and_b32_dpp v42, v33, v12 row_newbcast:15 row_mask:0xf bank_mask:0xf
    v_and_b32_dpp v43, v33, v13 row_newbcast:15 row_mask:0xf bank_mask:0xf
    v_mfma_f32_4x4x4bf16_1k v[48:51], a[120:121], v[40:41], v[48:51]
    v_mfma_f32_4x4x4bf16_1k v[52:55], a[122:123], v[40:41], v[52:55]
    v_and_b32_dpp v40, v34, v12 row_newbcast:0 row_mask:0xf bank_mask:0xf
    v_and_b32_dpp v41, v34, v13 row_newbcast:0 row_mask:0xf bank_mask:0xf
    v_mfma_f32_4x4x4bf16_1k v[48:51], a[124:125], v[42:43], v[48:51]
    v_mfma_f32_4x4x4bf16_1k v[52:55], a[126:127], v[42:43], v[52:55]
    v_and_b32_dpp v42, v34, v12 row_newbcast:1 row_mask:0xf bank_mask:0xf
    v_and_b32_dpp v43, v34, v13 row_newbcast:1 row_mask:0xf bank_mask:0xf
    s_waitcnt vmcnt(32)
    v_mfma_f32_4x4x4bf16_1k v[48:51], a[128:129], v[40:41], v[48:51]
    v_mfma_f32_4x4x4bf16_1k v[52:55], a[130:131], v[40:41], v[52:55]
    v_and_b32_dpp v40, v34, v12 row_newbcast:2 row_mask:0xf bank_mask:0xf
    v_and_b32_dpp v41, v34, v13 row_newbcast:2 row_mask:0xf bank_mask:0xf
    v_mfma_f32_4x4x4bf16_1k v[48:51], a[132:133], v[42:43], v[48:51]
    v_mfma_f32_4x4x4bf16_1k v[52:55], a[134:135], v[42:43], v[52:55]
    v_and_b32_dpp v42, v34, v12 row_newbcast:3 row_mask:0xf bank_mask:0xf
    v_and_b32_dpp v43, v34, v13 row_newbcast:3 row_mask:0xf bank_mask:0xf
    v_mfma_f32_4x4x4bf16_1k v[48:51], a[136:137], v[40:41], v[48:51]
    v_mfma_f32_4x4x4bf16_1k v[52:55], a[138:139], v[40:41], v[52:55]
    v_and_b32_dpp v40, v34, v12 row_newbcast:4 row_mask:0xf bank_mask:0xf
    v_and_b32_dpp v41, v34, v13 row_newbcast:4 row_mask:0xf bank_mask:0xf
    v_mfma_f32_4x4x4bf16_1k v[48:51], a[140:141], v[42:43], v[48:51]
    v_mfma_f32_4x4x4bf16_1k v[52:55], a[142:143], v[42:43], v[52:55]
    v_and_b32_dpp v42, v34, v12 row_newbcast:5 row_mask:0xf bank_mask:0xf
    v_and_b32_dpp v43, v34, v13 row_newbcast:5 row_mask:0xf bank_mask:0xf
    s_waitcnt vmcnt(28)
    v_mfma_f32_4x4x4bf16_1k v[48:51], a[144:145], v[40:41], v[48:51]
    v_mfma_f32_4x4x4bf16_1k v[52:55], a[146:147], v[40:41], v[52:55]
    v_and_b32_dpp v40, v34, v12 row_newbcast:6 row_mask:0xf bank_mask:0xf
    v_and_b32_dpp v41, v34, v13 row_newbcast:6 row_mask:0xf bank_mask:0xf
    v_mfma_f32_4x4x4bf16_1k v[48:51], a[148:149], v[42:43], v[48:51]
    v_mfma_f32_4x4x4bf16_1k v[52:55], a[150:151], v[42:43], v[52:55]
    v_and_b32_dpp v42, v34, v12 row_newbcast:7 row_mask:0xf bank_mask:0xf
    v_and_b32_dpp v43, v34, v13 row_newbcast:7 row_mask:0xf bank_mask:0xf
    v_mfma_f32_4x4x4bf16_1k v[48:51], a[152:153], v[40:41], v[48:51]
    v_mfma_f32_4x4x4bf16_1k v[52:55], a[154:155], v[40:41], v[52:55]
    v_and_b32_dpp v40, v34, v12 row_newbcast:8 row_mask:0xf bank_mask:0xf
    v_and_b32_dpp v41, v34, v13 row_newbcast:8 row_mask:0xf bank_mask:0xf
    v_mfma_f32_4x4x4bf16_1k v[48:51], a[156:157], v[42:43], v[48:51]
    v_mfma_f32_4x4x4bf16_1k v[52:55], a[158:159], v[42:43], v[52:55]
    v_and_b32_dpp v42, v34, v12 row_newbcast:9 row_mask:0xf bank_mask:0xf
    v_and_b32_dpp v43, v34, v13 row_newbcast:9 row_mask:0xf bank_mask:0xf
    s_waitcnt vmcnt(24)
    v_mfma_f32_4x4x4bf16_1k v[48:51], a[160:161], v[40:41], v[48:51]
    v_mfma_f32_4x4x4bf16_1k v[52:55], a[162:163], v[40:41], v[52:55]
    v_and_b32_dpp v40, v34, v12 row_newbcast:10 row_mask:0xf bank_mask:0xf
    v_and_b32_dpp v41, v34, v13 row_newbcast:10 row_mask:0xf bank_mask:0xf
    v_mfma_f32_4x4x4bf16_1k v[48:51], a[164:165], v[42:43], v[48:51]
    v_mfma_f32_4x4x4bf16_1k v[52:55], a[166:167], v[42:43], v[52:55]
    v_and_b32_dpp v42, v34, v12 row_newbcast:11 row_mask:0xf bank_mask:0xf
    v_and_b32_dpp v43, v34, v13 row_newbcast:11 row_mask:0xf bank_mask:0xf
    v_mfma_f32_4x4x4bf16_1k v[48:51], a[168:169], v[40:41], v[48:51]
    v_mfma_f32_4x4x4bf16_1k v[52:55], a[170:171], v[40:41], v[52:55]
    v_and_b32_dpp v40, v34, v12 row_newbcast:12 row_mask:0xf bank_mask:0xf
    v_and_b32_dpp v41, v34, v13 row_newbcast:12 row_mask:0xf bank_mask:0xf
    v_mfma_f32_4x4x4bf16_1k v[48:51], a[172:173], v[42:43], v[48:51]
    v_mfma_f32_4x4x4bf16_1k v[52:55], a[174:175], v[42:43], v[52:55]
    v_and_b32_dpp v42, v34, v12 row_newbcast:13 row_mask:0xf bank_mask:0xf
    v_and_b32_dpp v43, v34, v13 row_newbcast:13 row_mask:0xf bank_mask:0xf
    s_waitcnt vmcnt(20)
    v_mfma_f32_4x4x4bf16_1k v[48:51], a[176:177], v[40:41], v[48:51]
    v_mfma_f32_4x4x4bf16_1k v[52:55], a[178:179], v[40:41], v[52:55]
    v_and_b32_dpp v40, v34, v12 row_newbcast:14 row_mask:0xf bank_mask:0xf
    v_and_b32_dpp v41, v34, v13 row_newbcast:14 row_mask:0xf bank_mask:0xf
    v_mfma_f32_4x4x4bf16_1k v[48:51], a[180:181], v[42:43], v[48:51]
    v_mfma_f32_4x4x4bf16_1k v[52:55], a[182:183], v[42:43], v[52:55]
    v_and_b32_dpp v42, v34, v12 row_newbcast:15 row_mask:0xf bank_mask:0xf
    v_and_b32_dpp v43, v34, v13 row_newbcast:15 row_mask:0xf bank_mask:0xf
    v_mfma_f32_4x4x4bf16_1k v[48:51], a[184:185], v[40:41], v[48:51]
    v_mfma_f32_4x4x4bf16_1k v[52:55], a[186:187], v[40:41], v[52:55]
    v_and_b32_dpp v40, v35, v12 row_newbcast:0 row_mask:0xf bank_mask:0xf
    v_and_b32_dpp v41, v35, v13 row_newbcast:0 row_mask:0xf bank_mask:0xf
    v_mfma_f32_4x4x4bf16_1k v[48:51], a[188:189], v[42:43], v[48:51]
    v_mfma_f32_4x4x4bf16_1k v[52:55], a[190:191], v[42:43], v[52:55]
    v_and_b32_dpp v42, v35, v12 row_newbcast:1 row_mask:0xf bank_mask:0xf
    v_and_b32_dpp v43, v35, v13 row_newbcast:1 row_mask:0xf bank_mask:0xf
    s_waitcnt vmcnt(16)
    v_mfma_f32_4x4x4bf16_1k v[48:51], a[192:193], v[40:41], v[48:51]
    v_mfma_f32_4x4x4bf16_1k v[52:55], a[194:195], v[40:41], v[52:55]
    v_and_b32_dpp v40, v35, v12 row_newbcast:2 row_mask:0xf bank_mask:0xf
    v_and_b32_dpp v41, v35, v13 row_newbcast:2 row_mask:0xf bank_mask:0xf
    v_mfma_f32_4x4x4bf16_1k v[48:51], a[196:197], v[42:43], v[48:51]
    v_mfma_f32_4x4x4bf16_1k v[52:55], a[198:199], v[42:43], v[52:55]
    v_and_b32_dpp v42, v35, v12 row_newbcast:3 row_mask:0xf bank_mask:0xf
    v_and_b32_dpp v43, v35, v13 row_newbcast:3 row_mask:0xf bank_mask:0xf
    v_mfma_f32_4x4x4bf16_1k v[48:51], a[200:201], v[40:41], v[48:51]
    v_mfma_f32_4x4x4bf16_1k v[52:55], a[202:203], v[40:41], v[52:55]
    v_and_b32_dpp v40, v35, v12 row_newbcast:4 row_mask:0xf bank_mask:0xf
    v_and_b32_dpp v41, v35, v13 row_newbcast:4 row_mask:0xf bank_mask:0xf
    v_mfma_f32_4x4x4bf16_1k v[48:51], a[204:205], v[42:43], v[48:51]
    v_mfma_f32_4x4x4bf16_1k v[52:55], a[206:207], v[42:43], v[52:55]
    v_and_b32_dpp v42, v35, v12 row_newbcast:5 row_mask:0xf bank_mask:0xf
    v_and_b32_dpp v43, v35, v13 row_newbcast:5 row_mask:0xf bank_mask:0xf
    s_waitcnt vmcnt(12)
    v_mfma_f32_4x4x4bf16_1k v[48:51], a[208:209], v[40:41], v[48:51]
    v_mfma_f32_4x4x4bf16_1k v[52:55], a[210:211], v[40:41], v[52:55]
    v_and_b32_dpp v40, v35, v12 row_newbcast:6 row_mask:0xf bank_mask:0xf
    v_and_b32_dpp v41, v35, v13 row_newbcast:6 row_mask:0xf bank_mask:0xf
    v_mfma_f32_4x4x4bf16_1k v[48:51], a[212:213], v[42:43], v[48:51]
    v_mfma_f32_4x4x4bf16_1k v[52:55], a[214:215], v[42:43], v[52:55]
    v_and_b32_dpp v42, v35, v12 row_newbcast:7 row_mask:0xf bank_mask:0xf
    v_and_b32_dpp v43, v35, v13 row_newbcast:7 row_mask:0xf bank_mask:0xf
    v_mfma_f32_4x4x4bf16_1k v[48:51], a[216:217], v[40:41], v[48:51]
    v_mfma_f32_4x4x4bf16_1k v[52:55], a[218:219], v[40:41], v[52:55]
    v_and_b32_dpp v40, v35, v12 row_newbcast:8 row_mask:0xf bank_mask:0xf
    v_and_b32_dpp v41, v35, v13 row_newbcast:8 row_mask:0xf bank_mask:0xf
    v_mfma_f32_4x4x4bf16_1k v[48:51], a[220:221], v[42:43], v[48:51]
    v_mfma_f32_4x4x4bf16_1k v[52:55], a[222:223], v[42:43], v[52:55]
    v_and_b32_dpp v42, v35, v12 row_newbcast:9 row_mask:0xf bank_mask:0xf
    v_and_b32_dpp v43, v35, v13 row_newbcast:9 row_mask:0xf bank_mask:0xf
    s_waitcnt vmcnt(8)
    v_mfma_f32_4x4x4bf16_1k v[48:51], a[224:225], v[40:41], v[48:51]
    v_mfma_f32_4x4x4bf16_1k v[52:55], a[226:227], v[40:41], v[52:55]
    v_and_b32_dpp v40, v35, v12 row_newbcast:10 row_mask:0xf bank_mask:0xf
    v_and_b32_dpp v41, v35, v13 row_newbcast:10 row_mask:0xf bank_mask:0xf
    v_mfma_f32_4x4x4bf16_1k v[48:51], a[228:229], v[42:43], v[48:51]
    v_mfma_f32_4x4x4bf16_1k v[52:55], a[230:231], v[42:43], v[52:55]
    v_and_b32_dpp v42, v35, v12 row_newbcast:11 row_mask:0xf bank_mask:0xf
    v_and_b32_dpp v43, v35, v13 row_newbcast:11 row_mask:0xf bank_mask:0xf
    v_mfma_f32_4x4x4bf16_1k v[48:51], a[232:233], v[40:41], v[48:51]
    v_mfma_f32_4x4x4bf16_1k v[52:55], a[234:235], v[40:41], v[52:55]
    v_and_b32_dpp v40, v35, v12 row_newbcast:12 row_mask:0xf bank_mask:0xf
    v_and_b32_dpp v41, v35, v13 row_newbcast:12 row_mask:0xf bank_mask:0xf
    v_mfma_f32_4x4x4bf16_1k v[48:51], a[236:237], v[42:43], v[48:51]
    v_mfma_f32_4x4x4bf16_1k v[52:55], a[238:239], v[42:43], v[52:55]
    v_and_b32_dpp v42, v35, v12 row_newbcast:13 row_mask:0xf bank_mask:0xf
    v_and_b32_dpp v43, v35, v13 row_newbcast:13 row_mask:0xf bank_mask:0xf
    s_waitcnt vmcnt(4)
    v_mfma_f32_4x4x4bf16_1k v[48:51], a[240:241], v[40:41], v[48:51]
    v_mfma_f32_4x4x4bf16_1k v[52:55], a[242:243], v[40:41], v[52:55]
    v_and_b32_dpp v40, v35, v12 row_newbcast:14 row_mask:0xf bank_mask:0xf
    v_and_b32_dpp v41, v35, v13 row_newbcast:14 row_mask:0xf bank_mask:0xf
    v_mfma_f32_4x4x4bf16_1k v[48:51], a[244:245], v[42:43], v[48:51]
    v_mfma_f32_4x4x4bf16_1k v[52:55], a[246:247], v[42:43], v[52:55]
    v_and_b32_dpp v42, v35, v12 row_newbcast:15 row_mask:0xf bank_mask:0xf
    v_and_b32_dpp v43, v35, v13 row_newbcast:15 row_mask:0xf bank_mask:0xf
    v_mfma_f32_4x4x4bf16_1k v[48:51], a[248:249], v[40:41], v[48:51]
    v_mfma_f32_4x4x4bf16_1k v[52:55], a[250:251], v[40:41], v[52:55]
    s_nop 0
    v_mfma_f32_4x4x4bf16_1k v[48:51], a[252:253], v[42:43], v[48:51]
    v_mfma_f32_4x4x4bf16_1k v[52:55], a[254:255], v[42:43], v[52:55]
    v_mov_b32 v38, v37
    s_nop 1
    v_permlane32_swap_b32 v37, v38
    v_add_f32 v37, v37, v38
    v_mov_b32 v38, v37
    s_nop 1
    v_permlane16_swap_b32 v37, v38
    v_add_f32 v37, v37, v38
    v_permlane32_swap_b32 v48, v52
    v_permlane32_swap_b32 v49, v53
    v_permlane32_swap_b32 v50, v54
    v_permlane32_swap_b32 v51, v55
    v_pk_add_f32 v[48:49], v[48:49], v[52:53]
    v_pk_add_f32 v[50:51], v[50:51], v[54:55]
    s_nop 0
    v_permlane16_swap_b32 v48, v49
    v_permlane16_swap_b32 v50, v51
    v_add_f32 v48, v48, v49
    v_add_f32 v50, v50, v51
    ds_write_b32 v14, v48
    ds_write_b32 v14, v50 offset:64
    s_lshl_b32 s78, s68, 3
    s_add_u32 s78, s78, 156160
    v_mov_b32 v38, s78
    s_mov_b64 exec, 1
    ds_write_b64 v38, v[36:37]
    s_mov_b64 exec, -1
    v_add_u32 v45, 151552, v1
    v_mov_b32 v44, 156160
    s_waitcnt lgkmcnt(0)
    s_barrier
    s_cmp_lg_u32 s68, 0
    s_cbranch_scc1 L_nw0_85
    ds_read_b128 v[24:27], v44
    ds_read_b128 v[28:31], v44 offset:16
    ds_read_b128 v[8:11], v45 offset:0
    ds_read_b128 v[12:15], v45 offset:1024
    ds_read_b128 v[16:19], v45 offset:2048
    ds_read_b128 v[20:23], v45 offset:3072
    s_waitcnt lgkmcnt(4)
    v_max3_f32 v32, v24, v26, v28
    v_max_f32 v32, v32, v30
    v_sub_f32 v24, v24, v32
    v_sub_f32 v26, v26, v32
    v_sub_f32 v28, v28, v32
    v_sub_f32 v30, v30, v32
    v_exp_f32 v24, v24
    v_exp_f32 v26, v26
    v_exp_f32 v28, v28
    v_exp_f32 v30, v30
    v_mul_f32 v33, v24, v25
    v_fmac_f32 v33, v26, v27
    v_fmac_f32 v33, v28, v29
    v_fmac_f32 v33, v30, v31
    s_waitcnt lgkmcnt(0)
    v_pk_mul_f32 v[8:9], v[8:9], v[24:25] op_sel_hi:[1,0]
    v_pk_mul_f32 v[10:11], v[10:11], v[24:25] op_sel_hi:[1,0]
    v_pk_fma_f32 v[8:9], v[12:13], v[26:27], v[8:9] op_sel_hi:[1,0,1]
    v_pk_fma_f32 v[10:11], v[14:15], v[26:27], v[10:11] op_sel_hi:[1,0,1]
    v_pk_fma_f32 v[8:9], v[16:17], v[28:29], v[8:9] op_sel_hi:[1,0,1]
    v_pk_fma_f32 v[10:11], v[18:19], v[28:29], v[10:11] op_sel_hi:[1,0,1]
    v_pk_fma_f32 v[8:9], v[20:21], v[30:31], v[8:9] op_sel_hi:[1,0,1]
    v_pk_fma_f32 v[10:11], v[22:23], v[30:31], v[10:11] op_sel_hi:[1,0,1]
    s_mov_b32 exec_lo, -1
    s_mov_b32 exec_hi, 0
    s_cmp_eq_u32 s34, 0
    s_cbranch_scc1 L_gst_86
    buffer_store_dwordx4 v[8:11], v1, s[4:7], s85 offen
    s_mov_b64 exec, 1
    buffer_store_dwordx2 v[32:33], off, s[4:7], s86
    s_branch L_gste_87
L_gst_86:
    buffer_store_dwordx4 v[8:11], v1, s[4:7], s85 offen sc1
    s_mov_b64 exec, 1
    buffer_store_dwordx2 v[32:33], off, s[4:7], s86 sc1
L_gste_87:
    s_mov_b64 exec, -1
L_nw0_85:
    s_cmp_eq_u32 s74, 0
    s_cbranch_scc1 L_nit0_88
    s_cmp_ge_u32 s70, 5
    s_cbranch_scc1 L_ns5_89
    s_mov_b32 s8, s60
    s_mov_b32 s9, s61
    s_mov_b32 s10, 5242880
    s_mov_b32 s11, 0x20000
    s_mul_i32 s79, s69, 163840
    s_mul_i32 s99, s68, 40960
    s_add_u32 s79, s79, s99
    s_mul_i32 s99, s70, 256
    s_add_u32 s79, s79, s99
    v_lshrrev_b32 v62, 4, v0
    s_mov_b32 s99, 1280
    v_mul_lo_u32 v62, v62, s99
    v_and_b32 v63, 0xf0, v1
    v_add_u32 v62, v62, v63
    s_add_u32 s78, s79, 0
    buffer_load_dwordx4 v[28:31], v62, s[8:11], s78 offen nt
    s_add_u32 s78, s79, 5120
    buffer_load_dwordx4 v[32:35], v62, s[8:11], s78 offen nt
    s_add_u32 s78, s79, 10240
    buffer_load_dwordx4 v[36:39], v62, s[8:11], s78 offen nt
    s_add_u32 s78, s79, 15360
    buffer_load_dwordx4 v[40:43], v62, s[8:11], s78 offen nt
    s_add_u32 s78, s79, 20480
    buffer_load_dwordx4 v[44:47], v62, s[8:11], s78 offen nt
    s_add_u32 s78, s79, 25600
    buffer_load_dwordx4 v[48:51], v62, s[8:11], s78 offen nt
    s_add_u32 s78, s79, 30720
    buffer_load_dwordx4 v[52:55], v62, s[8:11], s78 offen nt
    s_add_u32 s78, s79, 35840
    buffer_load_dwordx4 v[56:59], v62, s[8:11], s78 offen nt
L_ns5_89:
L_nit0_88:
    s_cmp_ge_u32 s70, 5
    s_cbranch_scc1 L_ns5_90
    s_add_u32 s81, s77, 5111808
    s_mul_i32 s99, s69, 4096
    s_add_u32 s81, s81, s99
    s_add_u32 s82, s77, 5287936
    s_mul_i32 s99, s69, 128
    s_add_u32 s82, s82, s99
    s_add_u32 s83, s77, 5242880
    s_mul_i32 s99, s69, 1280
    s_add_u32 s83, s83, s99
    s_mul_i32 s99, s70, 256
    s_add_u32 s83, s83, s99
    s_add_u32 s84, s77, 5292032
    s_mul_i32 s99, s69, 128
    s_add_u32 s84, s84, s99
    v_and_b32 v26, 7, v0
    v_lshlrev_b32 v27, 2, v26
    v_lshlrev_b32 v26, 3, v26
    v_lshrrev_b32 v60, 4, v0
    v_add_u32 v60, v60, v27
    s_lshl_b32 s96, s68, 5
    v_add_u32 v60, s96, v60
    v_lshlrev_b32 v60, 1, v60
    v_add_u32 v60, 155648, v60
    v_lshlrev_b32 v61, 3, v0
    v_add_u32 v62, 155648, v61
    v_add_u32 v63, 147456, v1
    s_cmp_eq_u32 s74, 0
    s_cbranch_scc1 L_nit0_91
    s_waitcnt vmcnt(8)
    s_branch L_gackk_92
L_nit0_91:
    s_cmp_eq_u32 s34, 0
    s_cbranch_scc1 L_gack_93
    s_waitcnt vmcnt(2)
    s_branch L_gack2_94
L_gack_93:
    s_waitcnt vmcnt(0)
L_gack2_94:
L_gackk_92:
    s_cmp_eq_u32 s68, 0
    s_cbranch_scc1 L_w0poll_96
    s_cmp_lg_u32 s74, 0
    s_cbranch_scc1 L_nit1_97
    v_add_u32 v27, s20, v1
    ds_read_b128 v[28:31], v27 offset:0
    ds_read_b128 v[32:35], v27 offset:1024
    ds_read_b128 v[36:39], v27 offset:2048
    ds_read_b128 v[40:43], v27 offset:3072
    ds_read_b128 v[44:47], v27 offset:4096
    ds_read_b128 v[48:51], v27 offset:5120
    ds_read_b128 v[52:55], v27 offset:6144
    ds_read_b128 v[56:59], v27 offset:7168
L_nit1_97:
    s_branch L_nopoll_95
L_w0poll_96:
    buffer_load_dwordx4 v[8:11], v1, s[4:7], s81 offen offset:0 sc1
    buffer_load_dwordx4 v[12:15], v1, s[4:7], s81 offen offset:1024 sc1
    buffer_load_dwordx4 v[16:19], v1, s[4:7], s81 offen offset:2048 sc1
    buffer_load_dwordx4 v[20:23], v1, s[4:7], s81 offen offset:3072 sc1
    buffer_load_dwordx2 v[24:25], v26, s[4:7], s82 offen sc1
    s_cmp_lg_u32 s74, 0
    s_cbranch_scc1 L_nit1_101
    v_add_u32 v27, s20, v1
    ds_read_b128 v[28:31], v27 offset:0
    ds_read_b128 v[32:35], v27 offset:1024
    ds_read_b128 v[36:39], v27 offset:2048
    ds_read_b128 v[40:43], v27 offset:3072
    ds_read_b128 v[44:47], v27 offset:4096
    ds_read_b128 v[48:51], v27 offset:5120
    ds_read_b128 v[52:55], v27 offset:6144
    ds_read_b128 v[56:59], v27 offset:7168
L_nit1_101:
    s_branch L_chk_99
L_retry_98:
    s_sub_u32 s75, s75, 1
    s_cbranch_scc0 L_retry_98_go
    s_mov_b32 s75, 0
    s_branch L_done_100
L_retry_98_go:
    buffer_load_dwordx4 v[8:11], v1, s[4:7], s81 offen offset:0 sc1
    buffer_load_dwordx4 v[12:15], v1, s[4:7], s81 offen offset:1024 sc1
    buffer_load_dwordx4 v[16:19], v1, s[4:7], s81 offen offset:2048 sc1
    buffer_load_dwordx4 v[20:23], v1, s[4:7], s81 offen offset:3072 sc1
    buffer_load_dwordx2 v[24:25], v26, s[4:7], s82 offen sc1
L_chk_99:
    s_waitcnt vmcnt(0)
    v_max3_u32 v27, v8, v9, v10
    v_max3_u32 v27, v27, v11, v12
    v_max3_u32 v27, v27, v13, v14
    v_max3_u32 v27, v27, v15, v16
    v_max3_u32 v27, v27, v17, v18
    v_max3_u32 v27, v27, v19, v20
    v_max3_u32 v27, v27, v21, v22
    v_max3_u32 v27, v27, v23, v24
    v_max_u32 v27, v27, v25
    v_cmp_eq_u32 vcc, -1, v27
    s_nop 3
    s_cbranch_vccnz L_retry_98
L_done_100:
    v_mov_b32 v26, v24
    s_nop 1
    v_max_f32_dpp v26, v26, v26 quad_perm:[1,0,3,2] row_mask:0xf bank_mask:0xf
    s_nop 1
    v_max_f32_dpp v26, v26, v26 quad_perm:[2,3,0,1] row_mask:0xf bank_mask:0xf
    s_nop 1
    v_max_f32_dpp v26, v26, v26 row_half_mirror row_mask:0xf bank_mask:0xf
    v_sub_f32 v24, v24, v26
    v_exp_f32 v24, v24
    s_nop 0
    v_mul_f32 v25, v24, v25
    s_nop 1
    v_add_f32_dpp v25, v25, v25 quad_perm:[1,0,3,2] row_mask:0xf bank_mask:0xf
    s_nop 1
    v_add_f32_dpp v25, v25, v25 quad_perm:[2,3,0,1] row_mask:0xf bank_mask:0xf
    s_nop 1
    v_add_f32_dpp v25, v25, v25 row_half_mirror row_mask:0xf bank_mask:0xf
    v_rcp_f32 v25, v25
    s_nop 0
    v_mul_f32 v24, v24, v25
    s_nop 1
    v_mov_b32_dpp v26, v24 row_newbcast:0 row_mask:0x3 bank_mask:0xf
    s_nop 1
    v_mov_b32_dpp v26, v24 row_newbcast:1 row_mask:0xc bank_mask:0xf
    v_pk_mul_f32 v[8:9], v[8:9], v[26:27] op_sel_hi:[1,0]
    v_pk_mul_f32 v[10:11], v[10:11], v[26:27] op_sel_hi:[1,0]
    v_mov_b32_dpp v27, v24 row_newbcast:2 row_mask:0x3 bank_mask:0xf
    s_nop 1
    v_mov_b32_dpp v27, v24 row_newbcast:3 row_mask:0xc bank_mask:0xf
    v_pk_fma_f32 v[8:9], v[12:13], v[26:27], v[8:9] op_sel:[0,1,0] op_sel_hi:[1,1,1]
    v_pk_fma_f32 v[10:11], v[14:15], v[26:27], v[10:11] op_sel:[0,1,0] op_sel_hi:[1,1,1]
    v_mov_b32_dpp v26, v24 row_newbcast:4 row_mask:0x3 bank_mask:0xf
    s_nop 1
    v_mov_b32_dpp v26, v24 row_newbcast:5 row_mask:0xc bank_mask:0xf
    v_pk_fma_f32 v[8:9], v[16:17], v[26:27], v[8:9] op_sel_hi:[1,0,1]
    v_pk_fma_f32 v[10:11], v[18:19], v[26:27], v[10:11] op_sel_hi:[1,0,1]
    v_mov_b32_dpp v27, v24 row_newbcast:6 row_mask:0x3 bank_mask:0xf
    s_nop 1
    v_mov_b32_dpp v27, v24 row_newbcast:7 row_mask:0xc bank_mask:0xf
    v_pk_fma_f32 v[8:9], v[20:21], v[26:27], v[8:9] op_sel:[0,1,0] op_sel_hi:[1,1,1]
    v_pk_fma_f32 v[10:11], v[22:23], v[26:27], v[10:11] op_sel:[0,1,0] op_sel_hi:[1,1,1]
    v_mov_b32 v12, v8
    v_mov_b32 v13, v9
    v_mov_b32 v14, v10
    v_mov_b32 v15, v11
    v_permlane32_swap_b32 v8, v12
    v_permlane32_swap_b32 v9, v13
    v_permlane32_swap_b32 v10, v14
    v_permlane32_swap_b32 v11, v15
    v_add_f32 v8, v8, v12
    v_add_f32 v9, v9, v13
    v_add_f32 v10, v10, v14
    v_add_f32 v11, v11, v15
    v_cvt_pk_bf16_f32 v12, v8, v9
    v_cvt_pk_bf16_f32 v13, v10, v11
    ds_write_b64 v62, v[12:13]
    s_waitcnt lgkmcnt(0)
L_nopoll_95:
    s_barrier
    ds_read_u16 v8, v60
    s_waitcnt vmcnt(0)
    s_waitcnt lgkmcnt(0)
    v_lshl_or_b32 v8, v8, 16, v8
    s_nop 1
    v_and_b32_dpp v12, v8, v2 row_newbcast:0 row_mask:0xf bank_mask:0xf
    v_and_b32_dpp v13, v8, v3 row_newbcast:0 row_mask:0xf bank_mask:0xf
    v_and_b32_dpp v14, v8, v4 row_newbcast:0 row_mask:0xf bank_mask:0xf
    v_and_b32_dpp v15, v8, v5 row_newbcast:0 row_mask:0xf bank_mask:0xf
    v_and_b32_dpp v16, v8, v2 row_newbcast:1 row_mask:0xf bank_mask:0xf
    v_and_b32_dpp v17, v8, v3 row_newbcast:1 row_mask:0xf bank_mask:0xf
    v_and_b32_dpp v18, v8, v4 row_newbcast:1 row_mask:0xf bank_mask:0xf
    v_and_b32_dpp v19, v8, v5 row_newbcast:1 row_mask:0xf bank_mask:0xf
    v_mfma_f32_16x16x32_bf16 v[20:23], v[28:31], v[12:15], 0
    v_and_b32_dpp v12, v8, v2 row_newbcast:2 row_mask:0xf bank_mask:0xf
    v_and_b32_dpp v13, v8, v3 row_newbcast:2 row_mask:0xf bank_mask:0xf
    v_and_b32_dpp v14, v8, v4 row_newbcast:2 row_mask:0xf bank_mask:0xf
    v_and_b32_dpp v15, v8, v5 row_newbcast:2 row_mask:0xf bank_mask:0xf
    v_mfma_f32_16x16x32_bf16 v[20:23], v[32:35], v[16:19], v[20:23]
    v_and_b32_dpp v16, v8, v2 row_newbcast:3 row_mask:0xf bank_mask:0xf
    v_and_b32_dpp v17, v8, v3 row_newbcast:3 row_mask:0xf bank_mask:0xf
    v_and_b32_dpp v18, v8, v4 row_newbcast:3 row_mask:0xf bank_mask:0xf
    v_and_b32_dpp v19, v8, v5 row_newbcast:3 row_mask:0xf bank_mask:0xf
    v_mfma_f32_16x16x32_bf16 v[20:23], v[36:39], v[12:15], v[20:23]
    v_and_b32_dpp v12, v8, v2 row_newbcast:4 row_mask:0xf bank_mask:0xf
    v_and_b32_dpp v13, v8, v3 row_newbcast:4 row_mask:0xf bank_mask:0xf
    v_and_b32_dpp v14, v8, v4 row_newbcast:4 row_mask:0xf bank_mask:0xf
    v_and_b32_dpp v15, v8, v5 row_newbcast:4 row_mask:0xf bank_mask:0xf
    v_mfma_f32_16x16x32_bf16 v[20:23], v[40:43], v[16:19], v[20:23]
    v_and_b32_dpp v16, v8, v2 row_newbcast:5 row_mask:0xf bank_mask:0xf
    v_and_b32_dpp v17, v8, v3 row_newbcast:5 row_mask:0xf bank_mask:0xf
    v_and_b32_dpp v18, v8, v4 row_newbcast:5 row_mask:0xf bank_mask:0xf
    v_and_b32_dpp v19, v8, v5 row_newbcast:5 row_mask:0xf bank_mask:0xf
    v_mfma_f32_16x16x32_bf16 v[20:23], v[44:47], v[12:15], v[20:23]
    v_and_b32_dpp v12, v8, v2 row_newbcast:6 row_mask:0xf bank_mask:0xf
    v_and_b32_dpp v13, v8, v3 row_newbcast:6 row_mask:0xf bank_mask:0xf
    v_and_b32_dpp v14, v8, v4 row_newbcast:6 row_mask:0xf bank_mask:0xf
    v_and_b32_dpp v15, v8, v5 row_newbcast:6 row_mask:0xf bank_mask:0xf
    v_mfma_f32_16x16x32_bf16 v[20:23], v[48:51], v[16:19], v[20:23]
    v_and_b32_dpp v16, v8, v2 row_newbcast:7 row_mask:0xf bank_mask:0xf
    v_and_b32_dpp v17, v8, v3 row_newbcast:7 row_mask:0xf bank_mask:0xf
    v_and_b32_dpp v18, v8, v4 row_newbcast:7 row_mask:0xf bank_mask:0xf
    v_and_b32_dpp v19, v8, v5 row_newbcast:7 row_mask:0xf bank_mask:0xf
    v_mfma_f32_16x16x32_bf16 v[20:23], v[52:55], v[12:15], v[20:23]
    s_nop 0
    v_mfma_f32_16x16x32_bf16 v[20:23], v[56:59], v[16:19], v[20:23]
    s_nop 7
    ds_write_b32 v7, v20 offset:0
    ds_write_b32 v7, v21 offset:32
    ds_write_b32 v7, v22 offset:64
    ds_write_b32 v7, v23 offset:96
    s_waitcnt lgkmcnt(0)
    s_barrier
    s_cmp_lg_u32 s68, 0
    s_cbranch_scc1 L_nw0_102
    ds_read_b128 v[8:11], v63 offset:0
    ds_read_b128 v[12:15], v63 offset:1024
    ds_read_b128 v[16:19], v63 offset:2048
    ds_read_b128 v[20:23], v63 offset:3072
    s_waitcnt lgkmcnt(2)
    v_pk_add_f32 v[8:9], v[8:9], v[12:13]
    v_pk_add_f32 v[10:11], v[10:11], v[14:15]
    s_waitcnt lgkmcnt(0)
    v_pk_add_f32 v[16:17], v[16:17], v[20:21]
    v_pk_add_f32 v[18:19], v[18:19], v[22:23]
    v_pk_add_f32 v[8:9], v[8:9], v[16:17]
    v_pk_add_f32 v[10:11], v[10:11], v[18:19]
    v_cvt_pk_bf16_f32 v8, v8, v9
    v_cvt_pk_bf16_f32 v9, v10, v11
    s_mov_b32 exec_lo, -1
    s_mov_b32 exec_hi, 0
    buffer_store_dwordx2 v[8:9], v61, s[4:7], s83 offen sc1
    s_mov_b64 exec, -1
    s_cmp_lg_u32 s70, 0
    s_cbranch_scc1 L_nohx_103
    v_mov_b32 v10, 0
    s_mov_b64 exec, 1
    buffer_store_dword v10, off, s[4:7], s84 sc1
    s_mov_b64 exec, -1
L_nohx_103:
L_nw0_102:
L_ns5_90:
    s_cmp_lg_u32 s74, 0
    s_cbranch_scc1 L_go_104
    s_cmp_lg_u32 s69, 0
    s_cbranch_scc1 L_exit
L_go_104:
    s_add_u32 s81, s77, 5242880
    s_mul_i32 s99, s68, 10240
    s_add_u32 s81, s81, s99
    s_mul_i32 s99, s70, 160
    s_add_u32 s81, s81, s99
    s_add_u32 s82, s81, 5120
    s_add_u32 s83, s77, 5292032
    s_mul_i32 s99, s69, 128
    s_add_u32 s83, s83, s99
    v_and_b32 v8, 15, v0
    v_min_u32 v24, 9, v8
    v_lshlrev_b32 v24, 4, v24
    v_lshrrev_b32 v9, 4, v0
    v_mul_u32_u24 v25, 1280, v9
    v_add_u32 v24, v24, v25
    v_cmp_gt_u32 vcc, 5, v8
    v_mov_b32 v25, 0xffff0000
    s_nop 0
    v_cndmask_b32 v25, 0, v25, vcc
    v_lshl_add_u32 v9, v8, 2, v9
    s_mul_i32 s96, s68, 20
    v_add_u32 v9, s96, v9
    v_min_u32 v9, 127, v9
    v_lshlrev_b32 v9, 2, v9
    v_add_u32 v27, 151552, v9
    v_and_b32 v20, 0x3f803f80, v2
    v_and_b32 v21, 0x3f803f80, v3
    v_and_b32 v22, 0x3f803f80, v4
    v_and_b32 v23, 0x3f803f80, v5
    v_mov_b32 v32, 0
    v_mov_b32 v33, 0
    v_mov_b32 v34, 0
    v_mov_b32 v35, 0
    v_mov_b32_dpp v32, v2 row_shr:8 row_mask:0xf bank_mask:0xc
    v_mov_b32_dpp v33, v3 row_shr:8 row_mask:0xf bank_mask:0xc
    v_mov_b32_dpp v34, v4 row_shr:8 row_mask:0xf bank_mask:0xc
    v_mov_b32_dpp v35, v5 row_shr:8 row_mask:0xf bank_mask:0xc
    v_and_b32 v32, 0x3f803f80, v32
    v_and_b32 v33, 0x3f803f80, v33
    v_and_b32 v34, 0x3f803f80, v34
    v_and_b32 v35, 0x3f803f80, v35
    v_mov_b32 v36, v32
    v_mov_b32 v37, v33
    v_mov_b32 v38, v34
    v_mov_b32 v39, v35
    v_add_u32 v31, 147456, v1
    s_lshl_b32 s78, s68, 3
    s_add_u32 s78, s78, 156160
    v_mov_b32 v30, s78
    s_add_u32 s85, s77, 0
    s_mul_i32 s99, s71, 1024
    s_add_u32 s85, s85, s99
    s_add_u32 s86, s77, 335872
    s_mul_i32 s99, s69, 128
    s_add_u32 s86, s86, s99
    s_mul_i32 s99, s70, 8
    s_add_u32 s86, s86, s99
    s_cmp_eq_u32 s74, 0
    s_cbranch_scc1 L_nit0_105
    s_mov_b32 s8, s44
    s_mov_b32 s9, s45
    s_mov_b32 s10, 5242880
    s_mov_b32 s11, 0x20000
    s_mul_i32 s79, s70, 655360
    s_mul_i32 s99, s68, 163840
    s_add_u32 s79, s79, s99
    s_mul_i32 s99, s69, 256
    s_add_u32 s79, s79, s99
    v_lshrrev_b32 v16, 4, v0
    s_mov_b32 s99, 8192
    v_mul_lo_u32 v16, v16, s99
    v_and_b32 v17, 0xf0, v1
    v_add_u32 v16, v16, v17
    s_add_u32 s78, s79, 0
    buffer_load_dwordx4 v[44:47], v16, s[8:11], s78 offen nt
    s_add_u32 s78, s79, 32768
    buffer_load_dwordx4 v[48:51], v16, s[8:11], s78 offen nt
    s_add_u32 s78, s79, 65536
    buffer_load_dwordx4 v[52:55], v16, s[8:11], s78 offen nt
    s_add_u32 s78, s79, 98304
    buffer_load_dwordx4 v[56:59], v16, s[8:11], s78 offen nt
    s_add_u32 s78, s79, 131072
    buffer_load_dwordx4 v[60:63], v16, s[8:11], s78 offen nt
    s_waitcnt vmcnt(5)
    s_branch L_byit_106
L_nit0_105:
    s_waitcnt vmcnt(0)
L_byit_106:
    s_cmp_lg_u32 s68, 0
    s_cbranch_scc1 L_nohint_107
    s_cmp_lt_u32 s70, 5
    s_cbranch_scc1 L_nohint_107
L_hs_108:
    s_buffer_load_dword s80, s[4:7], s83 glc
    s_waitcnt lgkmcnt(0)
    s_cmp_lg_u32 s80, -1
    s_cbranch_scc1 L_hok_109
    s_sub_u32 s75, s75, 1
    s_cbranch_scc0 L_hs_108
    s_mov_b32 s75, 0
L_hok_109:
L_nohint_107:
    s_barrier
    buffer_load_dwordx4 v[8:11], v24, s[4:7], s81 offen sc1
    buffer_load_dwordx4 v[12:15], v24, s[4:7], s82 offen sc1
    s_branch L_chk_111
L_retry_110:
    s_sub_u32 s75, s75, 1
    s_cbranch_scc0 L_retry_110_go
    s_mov_b32 s75, 0
    s_branch L_done_112
L_retry_110_go:
    buffer_load_dwordx4 v[8:11], v24, s[4:7], s81 offen sc1
    buffer_load_dwordx4 v[12:15], v24, s[4:7], s82 offen sc1
L_chk_111:
    s_waitcnt vmcnt(0)
    v_max3_u32 v19, v8, v9, v10
    v_max3_u32 v19, v19, v11, v12
    v_max3_u32 v19, v19, v13, v14
    v_max_u32 v19, v19, v15
    v_cmp_eq_u32 vcc, -1, v19
    s_nop 3
    s_cbranch_vccnz L_retry_110
L_done_112:
    v_mfma_f32_16x16x32_bf16 v[40:43], v[8:11], v[20:23], 0
    v_mfma_f32_16x16x32_bf16 v[40:43], v[12:15], v[20:23], v[40:43]
    s_nop 7
    ds_write_b32 v7, v40 offset:4096
    ds_write_b32 v7, v41 offset:4128
    ds_write_b32 v7, v42 offset:4160
    ds_write_b32 v7, v43 offset:4192
    s_waitcnt lgkmcnt(0)
    s_barrier
    ds_read_b32 v16, v27 offset:0
    ds_read_b32 v17, v27 offset:1024
    ds_read_b32 v18, v27 offset:2048
    ds_read_b32 v19, v27 offset:3072
    s_waitcnt lgkmcnt(0)
    v_pk_add_f32 v[16:17], v[16:17], v[18:19]
    v_add_f32 v16, v16, v17
    v_cvt_pk_bf16_f32 v16, v16, v16
    v_and_b32 v16, 0xffff0000, v16
    v_add_f32 v16, v6, v16
    v_cvt_pk_bf16_f32 v26, v16, v16
    v_and_b32 v6, v26, v25
    s_cmp_eq_u32 s74, 0
    s_cbranch_scc1 L_final
    s_mov_b32 s74, 0
    s_mov_b32 s77, 5308416
    s_add_u32 s85, s85, 5308416
    s_add_u32 s86, s86, 5308416
    s_getpc_b64 s[96:97]
L_pc:
    s_sub_u32 s96, s96, L_pc-L_loop
    s_subb_u32 s97, s97, 0
    s_setpc_b64 s[96:97]
L_final:
    s_mov_b32 s8, s62
    s_mov_b32 s9, s63
    s_mov_b32 s10, 1280
    s_mov_b32 s11, 0x20000
    v_and_b32 v8, 15, v0
    v_lshrrev_b32 v9, 4, v0
    v_lshl_add_u32 v9, v8, 2, v9
    s_mul_i32 s78, s70, 80
    s_mul_i32 s79, s68, 20
    s_add_u32 s78, s78, s79
    v_add_u32 v9, s78, v9
    v_lshlrev_b32 v9, 1, v9
    v_cmp_gt_u32 vcc, 5, v8
    v_mov_b32 v10, 0x10000
    s_nop 0
    v_cndmask_b32 v9, v10, v9, vcc
    v_lshrrev_b32 v11, 16, v6
    buffer_store_short v11, v9, s[8:11], 0 offen
L_exit:
    s_waitcnt vmcnt(0)
L_end:
    s_endpgm
.section .rodata,"a"
.p2align 6
.amdhsa_kernel interleave_layers__compressed_kv_cla__mha_block_cached__decode_kernel
  .amdhsa_next_free_vgpr 512
  .amdhsa_next_free_sgpr 102
  .amdhsa_accum_offset 256
  .amdhsa_group_segment_fixed_size 0
  .amdhsa_kernarg_size 112
  .amdhsa_user_sgpr_count 2
  .amdhsa_user_sgpr_kernarg_segment_ptr 1
  .amdhsa_system_sgpr_workgroup_id_x 1
  .amdhsa_float_denorm_mode_32 3
.end_amdhsa_kernel
```
